```python
import torch

def _softmax(x, axis=-1):
    return torch.softmax(x, dim=axis)

def _gelu(x):
    return torch.nn.functional.gelu(x, approximate='tanh')

def _silu(x):
    return torch.nn.functional.silu(x)

def _sigmoid(x):
    return torch.sigmoid(x)

def _layernorm(x, axis=-1, eps=1e-05):
    m = x.mean(dim=axis, keepdim=True)
    v = x.var(dim=axis, keepdim=True, unbiased=False)
    return (x - m) / torch.sqrt(v + eps)

def _scatter_add(tgt, idx, src, axis=0):
    return tgt.clone().index_add_(axis, idx, src)

def _segment_sum(src, seg, n):
    out = torch.zeros((n,) + src.shape[1:], dtype=src.dtype)
    return out.index_add_(0, seg, src)

def _pad(x, pw):
    flat = tuple((v for pair in reversed(pw) for v in pair))
    return torch.nn.functional.pad(x, flat)
kernel_name = 'gather_scatter__molecular_angular_painn__graph'

def setup_inputs():

    _w = lambda a: (lambda t: t.to(torch.bfloat16) if t.is_floating_point() else t)(torch.as_tensor(a))
    N, deg, D = (25000, 16, 128)
    n_rbf = max(16, 4)
    E = N * deg
    cutoff = 5.0
    freqs = (torch.arange(1, n_rbf + 1) * torch.pi / cutoff).to(float)
    return {'sv': _w((lambda *s: torch.randn(*s, dtype=torch.bfloat16) * 0.4)(N, 4, D) * 0.3), 'pos': _w((lambda *s: torch.randn(*s, dtype=torch.bfloat16) * 3.2)(N, 3) * 1.2), 'src': _w((lambda lo, hi, *s: torch.randint(lo, hi, s))(0, N, E).to(torch.int64)), 'dst': _w((lambda lo, hi, *s: torch.randint(lo, hi, s))(0, N, E).to(torch.int64)), 'freqs': _w(freqs), 'w_phi1': _w((lambda *s: torch.randn(*s, dtype=torch.bfloat16) * 3.2)(D, D) / D ** 0.5), 'w_phi2': _w((lambda *s: torch.randn(*s, dtype=torch.bfloat16) * 3.2)(D, 3 * D) / D ** 0.5), 'w_rbf': _w((lambda *s: torch.randn(*s, dtype=torch.bfloat16) * 3.2)(n_rbf, 3 * D) / n_rbf ** 0.5)}

def reference(sv, pos, src, dst, freqs, w_phi1, w_phi2, w_rbf):
    N, _, D = sv.shape
    E = src.shape[0]
    PI, cutoff = (3.141592653589793, 5.0)
    s, v = (sv[:, 0, :].clone(), sv[:, 1:, :].clone())
    r_vec = pos[src] - pos[dst]
    d = torch.sqrt((r_vec * r_vec).sum(-1) + 1e-08)
    r_hat = r_vec / d[:, None]
    rbf = torch.sin(d[:, None] * freqs[None, :]) / d[:, None]
    fcut = 0.5 * (torch.cos(PI * d / cutoff) + 1.0)
    fcut = torch.where(d < cutoff, fcut, 0.0 * d)
    Wf = rbf @ w_rbf * fcut[:, None]
    phi = (_silu(s @ w_phi1) @ w_phi2)[src]
    m = phi * Wf
    m_s, m_vv, m_vr = (m[:, :D].clone(), m[:, D:2 * D].clone(), m[:, 2 * D:].clone())
    ds = _segment_sum(m_s, dst, N)
    dv_e = m_vv[:, None, :] * v[src] + m_vr[:, None, :] * r_hat[:, :, None]
    dv = _segment_sum(dv_e.reshape(E, 3 * D), dst, N).reshape(N, 3, D)
    return sv + torch.concatenate([ds[:, None, :], dv], axis=1)
```

```asm
; @launch kernel=ka_kernel grid=(256,1,1) block=(512,1,1) lds=157696
; @launch kernel=kb_kernel grid=(256,1,1) block=(512,1,1) lds=160320
.amdgcn_target "amdgcn-amd-amdhsa--gfx950"
.text
.globl ka_kernel
.p2align 8
.type ka_kernel,@function
ka_kernel:
    s_load_dwordx16 s[4:19], s[0:1], 0
    s_load_dwordx2 s[20:21], s[0:1], 80
    s_cmp_ge_u32 s2, 256
    s_cbranch_scc1 ka_exit
    v_lshrrev_b32 v1, 6, v0
    s_nop 0
    v_readfirstlane_b32 s23, v1
    v_and_b32 v1, 63, v0
    s_lshr_b32 s62, s2, 4
    s_lshl_b32 s22, s62, 3
    s_and_b32 s3, s2, 7
    s_or_b32 s22, s22, s3
    s_bitcmp1_b32 s2, 3
    s_cbranch_scc1 ka_h
    s_mul_i32 s44, s22, 12512
    v_lshl_add_u32 v20, v0, 4, s44
    s_add_u32 s45, s44, 8192
    v_lshl_add_u32 v21, v0, 3, s45
    s_add_u32 s45, s44, 12288
    v_lshl_add_u32 v22, v0, 2, s45
    v_mov_b32 v2, 0x40000000
    v_cmp_gt_u32 vcc, 56, v0
    s_nop 1
    v_cndmask_b32 v22, v2, v22, vcc
    v_lshlrev_b32 v2, 4, v1
    s_mul_i32 s45, s23, 19456
    s_add_u32 s46, s45, 19456
    s_mul_i32 s47, s62, 19
    s_lshr_b32 s47, s47, 4
    s_lshl_b32 s47, s47, 10
    s_add_u32 s47, s47, s45
    s_waitcnt lgkmcnt(0)
    s_mov_b32 s32, s6
    s_mov_b32 s33, s7
    s_mov_b32 s34, 150000
    s_mov_b32 s35, 0x00020000
    s_mov_b32 s24, s8
    s_mov_b32 s25, s9
    s_mov_b32 s26, 1600000
    s_mov_b32 s27, 0x00020000
    s_mov_b32 s28, s10
    s_mov_b32 s29, s11
    s_mov_b32 s30, 1600000
    s_mov_b32 s31, 0x00020000
    s_add_u32 m0, s47, 2048
    s_nop 0
    buffer_load_dwordx4 v2, s[32:35], s47 offen sc0 lds
    s_add_u32 s47, s47, 1024
    s_cmp_eq_u32 s47, s46
    s_cselect_b32 s47, s45, s47
    s_add_u32 m0, s47, 2048
    s_nop 0
    buffer_load_dwordx4 v2, s[32:35], s47 offen sc0 lds
    s_add_u32 s47, s47, 1024
    s_cmp_eq_u32 s47, s46
    s_cselect_b32 s47, s45, s47
    buffer_load_dwordx4 v[4:7], v20, s[24:27], 0 offen sc0
    buffer_load_dwordx4 v[12:15], v20, s[28:31], 0 offen sc0
    buffer_load_dwordx2 v[8:9], v21, s[24:27], 0 offen sc0
    buffer_load_dwordx2 v[16:17], v21, s[28:31], 0 offen sc0
    buffer_load_dword v10, v22, s[24:27], 0 offen sc0
    buffer_load_dword v18, v22, s[28:31], 0 offen sc0
    s_barrier
    s_add_u32 m0, s47, 2048
    s_nop 0
    buffer_load_dwordx4 v2, s[32:35], s47 offen sc0 lds
    s_add_u32 s47, s47, 1024
    s_cmp_eq_u32 s47, s46
    s_cselect_b32 s47, s45, s47
    s_add_u32 m0, s47, 2048
    s_nop 0
    buffer_load_dwordx4 v2, s[32:35], s47 offen sc0 lds
    s_add_u32 s47, s47, 1024
    s_cmp_eq_u32 s47, s46
    s_cselect_b32 s47, s45, s47
    s_add_u32 m0, s47, 2048
    s_nop 0
    buffer_load_dwordx4 v2, s[32:35], s47 offen sc0 lds
    s_add_u32 s47, s47, 1024
    s_cmp_eq_u32 s47, s46
    s_cselect_b32 s47, s45, s47
    s_add_u32 m0, s47, 2048
    s_nop 0
    buffer_load_dwordx4 v2, s[32:35], s47 offen sc0 lds
    s_add_u32 s47, s47, 1024
    s_cmp_eq_u32 s47, s46
    s_cselect_b32 s47, s45, s47
    s_add_u32 m0, s47, 2048
    s_nop 0
    buffer_load_dwordx4 v2, s[32:35], s47 offen sc0 lds
    s_add_u32 s47, s47, 1024
    s_cmp_eq_u32 s47, s46
    s_cselect_b32 s47, s45, s47
    s_add_u32 m0, s47, 2048
    s_nop 0
    buffer_load_dwordx4 v2, s[32:35], s47 offen sc0 lds
    s_add_u32 s47, s47, 1024
    s_cmp_eq_u32 s47, s46
    s_cselect_b32 s47, s45, s47
    s_add_u32 m0, s47, 2048
    s_nop 0
    buffer_load_dwordx4 v2, s[32:35], s47 offen sc0 lds
    s_add_u32 s47, s47, 1024
    s_cmp_eq_u32 s47, s46
    s_cselect_b32 s47, s45, s47
    s_add_u32 m0, s47, 2048
    s_nop 0
    buffer_load_dwordx4 v2, s[32:35], s47 offen sc0 lds
    s_add_u32 s47, s47, 1024
    s_cmp_eq_u32 s47, s46
    s_cselect_b32 s47, s45, s47
    s_add_u32 m0, s47, 2048
    s_nop 0
    buffer_load_dwordx4 v2, s[32:35], s47 offen sc0 lds
    s_add_u32 s47, s47, 1024
    s_cmp_eq_u32 s47, s46
    s_cselect_b32 s47, s45, s47
    s_add_u32 m0, s47, 2048
    s_nop 0
    buffer_load_dwordx4 v2, s[32:35], s47 offen sc0 lds
    s_add_u32 s47, s47, 1024
    s_cmp_eq_u32 s47, s46
    s_cselect_b32 s47, s45, s47
    s_add_u32 m0, s47, 2048
    s_nop 0
    buffer_load_dwordx4 v2, s[32:35], s47 offen sc0 lds
    s_add_u32 s47, s47, 1024
    s_cmp_eq_u32 s47, s46
    s_cselect_b32 s47, s45, s47
    s_add_u32 m0, s47, 2048
    s_nop 0
    buffer_load_dwordx4 v2, s[32:35], s47 offen sc0 lds
    s_add_u32 s47, s47, 1024
    s_cmp_eq_u32 s47, s46
    s_cselect_b32 s47, s45, s47
    s_add_u32 m0, s47, 2048
    s_nop 0
    buffer_load_dwordx4 v2, s[32:35], s47 offen sc0 lds
    s_add_u32 s47, s47, 1024
    s_cmp_eq_u32 s47, s46
    s_cselect_b32 s47, s45, s47
    s_add_u32 m0, s47, 2048
    s_nop 0
    buffer_load_dwordx4 v2, s[32:35], s47 offen sc0 lds
    s_add_u32 s47, s47, 1024
    s_cmp_eq_u32 s47, s46
    s_cselect_b32 s47, s45, s47
    s_add_u32 m0, s47, 2048
    s_nop 0
    buffer_load_dwordx4 v2, s[32:35], s47 offen sc0 lds
    s_add_u32 s47, s47, 1024
    s_cmp_eq_u32 s47, s46
    s_cselect_b32 s47, s45, s47
    s_add_u32 m0, s47, 2048
    s_nop 0
    buffer_load_dwordx4 v2, s[32:35], s47 offen sc0 lds
    s_add_u32 s47, s47, 1024
    s_cmp_eq_u32 s47, s46
    s_cselect_b32 s47, s45, s47
    s_add_u32 m0, s47, 2048
    s_nop 0
    buffer_load_dwordx4 v2, s[32:35], s47 offen sc0 lds
    v_lshlrev_b32 v3, 2, v0
    v_mov_b32 v2, 4
    v_cmp_gt_u32 vcc, 256, v0
    s_nop 1
    v_cndmask_b32 v23, 0, v2, vcc
    ds_write_b32 v3, v23
    v_cmp_gt_u32 s[46:47], s26, v20
    v_cmp_gt_u32 s[54:55], s26, v21
    v_cmp_gt_u32 s[58:59], s26, v22
    s_mov_b64 s[48:49], s[46:47]
    s_mov_b64 s[50:51], s[46:47]
    s_mov_b64 s[52:53], s[46:47]
    s_mov_b64 s[56:57], s[54:55]
    s_add_u32 s36, s20, 6815744
    s_addc_u32 s37, s21, 0
    s_mov_b32 s38, 2097152
    s_mov_b32 s39, 0x00020000
    s_add_u32 s40, s20, 10485760
    s_addc_u32 s41, s21, 0
    s_mov_b32 s42, 1605632
    s_mov_b32 s43, 0x00020000
    s_mov_b32 s44, 0xffff0000
    s_mov_b32 s45, 0x41c28000
    s_mov_b32 s64, 0x0000bf80
    s_mov_b32 s65, 0xbf800000
    s_movk_i32 s66, 2048
    s_waitcnt vmcnt(17)
    v_mad_u32_u24 v88, v4, 6, s66
    v_mad_u32_u24 v96, v12, 6, s66
    v_and_b32 v88, -4, v88
    v_and_b32 v96, -4, v96
    v_mul_u32_u24 v56, 10700, v12
    v_lshrrev_b32 v56, 20, v56
    v_lshlrev_b32 v80, 2, v56
    v_lshl_or_b32 v64, v12, 16, v4
    v_mad_u32_u24 v89, v5, 6, s66
    v_mad_u32_u24 v97, v13, 6, s66
    v_and_b32 v89, -4, v89
    v_and_b32 v97, -4, v97
    v_mul_u32_u24 v56, 10700, v13
    v_lshrrev_b32 v56, 20, v56
    v_lshlrev_b32 v81, 2, v56
    v_lshl_or_b32 v65, v13, 16, v5
    v_mad_u32_u24 v90, v6, 6, s66
    v_mad_u32_u24 v98, v14, 6, s66
    v_and_b32 v90, -4, v90
    v_and_b32 v98, -4, v98
    v_mul_u32_u24 v56, 10700, v14
    v_lshrrev_b32 v56, 20, v56
    v_lshlrev_b32 v82, 2, v56
    v_lshl_or_b32 v66, v14, 16, v6
    v_mad_u32_u24 v91, v7, 6, s66
    v_mad_u32_u24 v99, v15, 6, s66
    v_and_b32 v91, -4, v91
    v_and_b32 v99, -4, v99
    v_mul_u32_u24 v56, 10700, v15
    v_lshrrev_b32 v56, 20, v56
    v_lshlrev_b32 v83, 2, v56
    v_lshl_or_b32 v67, v15, 16, v7
    v_mad_u32_u24 v92, v8, 6, s66
    v_mad_u32_u24 v100, v16, 6, s66
    v_and_b32 v92, -4, v92
    v_and_b32 v100, -4, v100
    v_mul_u32_u24 v56, 10700, v16
    v_lshrrev_b32 v56, 20, v56
    v_lshlrev_b32 v84, 2, v56
    v_lshl_or_b32 v68, v16, 16, v8
    v_mad_u32_u24 v93, v9, 6, s66
    v_mad_u32_u24 v101, v17, 6, s66
    v_and_b32 v93, -4, v93
    v_and_b32 v101, -4, v101
    v_mul_u32_u24 v56, 10700, v17
    v_lshrrev_b32 v56, 20, v56
    v_lshlrev_b32 v85, 2, v56
    v_lshl_or_b32 v69, v17, 16, v9
    v_mad_u32_u24 v94, v10, 6, s66
    v_mad_u32_u24 v102, v18, 6, s66
    v_and_b32 v94, -4, v94
    v_and_b32 v102, -4, v102
    v_mul_u32_u24 v56, 10700, v18
    v_lshrrev_b32 v56, 20, v56
    v_lshlrev_b32 v86, 2, v56
    v_lshl_or_b32 v70, v18, 16, v10
    s_waitcnt vmcnt(0) lgkmcnt(0)
    s_barrier
    s_mov_b64 exec, s[58:59]
    ds_read2_b32 v[36:37], v94 offset1:1
    ds_read2_b32 v[52:53], v102 offset1:1
    s_mov_b64 exec, -1
    ds_read2_b32 v[24:25], v88 offset1:1
    ds_read2_b32 v[40:41], v96 offset1:1
    ds_read2_b32 v[26:27], v89 offset1:1
    ds_read2_b32 v[42:43], v97 offset1:1
    ds_read2_b32 v[28:29], v90 offset1:1
    ds_read2_b32 v[44:45], v98 offset1:1
    ds_read2_b32 v[30:31], v91 offset1:1
    ds_read2_b32 v[46:47], v99 offset1:1
    ds_read2_b32 v[32:33], v92 offset1:1
    ds_read2_b32 v[48:49], v100 offset1:1
    ds_read2_b32 v[34:35], v93 offset1:1
    ds_read2_b32 v[50:51], v101 offset1:1
    v_lshlrev_b32 v4, 4, v4
    v_lshlrev_b32 v12, 4, v12
    v_lshlrev_b32 v5, 4, v5
    v_lshlrev_b32 v13, 4, v13
    v_lshlrev_b32 v6, 4, v6
    v_lshlrev_b32 v14, 4, v14
    v_lshlrev_b32 v7, 4, v7
    v_lshlrev_b32 v15, 4, v15
    v_lshlrev_b32 v8, 4, v8
    v_lshlrev_b32 v16, 4, v16
    v_lshlrev_b32 v9, 4, v9
    v_lshlrev_b32 v17, 4, v17
    v_lshlrev_b32 v10, 4, v10
    v_lshlrev_b32 v18, 4, v18
    s_waitcnt lgkmcnt(12)
    v_alignbit_b32 v36, v37, v36, v10
    v_lshrrev_b32 v37, v10, v37
    v_alignbit_b32 v52, v53, v52, v18
    v_lshrrev_b32 v53, v18, v53
    v_lshlrev_b32 v56, 16, v36
    v_and_b32 v57, s44, v36
    v_lshlrev_b32 v58, 16, v37
    v_dot2_f32_bf16 v56, v52, s64, v56
    v_dot2_f32_bf16 v57, v52, s65, v57
    v_dot2_f32_bf16 v58, v53, s64, v58
    s_waitcnt lgkmcnt(10)
    v_alignbit_b32 v24, v25, v24, v4
    v_lshrrev_b32 v25, v4, v25
    v_alignbit_b32 v40, v41, v40, v12
    v_lshrrev_b32 v41, v12, v41
    v_mul_f32 v56, v56, v56
    v_fmac_f32 v56, v57, v57
    v_fmac_f32 v56, v58, v58
    v_cmp_gt_f32 vcc, s45, v56
    s_and_b64 s[58:59], s[58:59], vcc
    v_lshlrev_b32 v59, 16, v24
    v_and_b32 v60, s44, v24
    v_lshlrev_b32 v61, 16, v25
    v_dot2_f32_bf16 v59, v40, s64, v59
    v_dot2_f32_bf16 v60, v40, s65, v60
    v_dot2_f32_bf16 v61, v41, s64, v61
    s_waitcnt lgkmcnt(8)
    v_alignbit_b32 v26, v27, v26, v5
    v_lshrrev_b32 v27, v5, v27
    v_alignbit_b32 v42, v43, v42, v13
    v_lshrrev_b32 v43, v13, v43
    v_mul_f32 v59, v59, v59
    v_fmac_f32 v59, v60, v60
    v_fmac_f32 v59, v61, v61
    v_cmp_gt_f32 vcc, s45, v59
    s_and_b64 s[46:47], s[46:47], vcc
    v_lshlrev_b32 v56, 16, v26
    v_and_b32 v57, s44, v26
    v_lshlrev_b32 v58, 16, v27
    v_dot2_f32_bf16 v56, v42, s64, v56
    v_dot2_f32_bf16 v57, v42, s65, v57
    v_dot2_f32_bf16 v58, v43, s64, v58
    s_waitcnt lgkmcnt(6)
    v_alignbit_b32 v28, v29, v28, v6
    v_lshrrev_b32 v29, v6, v29
    v_alignbit_b32 v44, v45, v44, v14
    v_lshrrev_b32 v45, v14, v45
    v_mul_f32 v56, v56, v56
    v_fmac_f32 v56, v57, v57
    v_fmac_f32 v56, v58, v58
    v_cmp_gt_f32 vcc, s45, v56
    s_and_b64 s[48:49], s[48:49], vcc
    v_lshlrev_b32 v59, 16, v28
    v_and_b32 v60, s44, v28
    v_lshlrev_b32 v61, 16, v29
    v_dot2_f32_bf16 v59, v44, s64, v59
    v_dot2_f32_bf16 v60, v44, s65, v60
    v_dot2_f32_bf16 v61, v45, s64, v61
    s_waitcnt lgkmcnt(4)
    v_alignbit_b32 v30, v31, v30, v7
    v_lshrrev_b32 v31, v7, v31
    v_alignbit_b32 v46, v47, v46, v15
    v_lshrrev_b32 v47, v15, v47
    v_mul_f32 v59, v59, v59
    v_fmac_f32 v59, v60, v60
    v_fmac_f32 v59, v61, v61
    v_cmp_gt_f32 vcc, s45, v59
    s_and_b64 s[50:51], s[50:51], vcc
    v_lshlrev_b32 v56, 16, v30
    v_and_b32 v57, s44, v30
    v_lshlrev_b32 v58, 16, v31
    v_dot2_f32_bf16 v56, v46, s64, v56
    v_dot2_f32_bf16 v57, v46, s65, v57
    v_dot2_f32_bf16 v58, v47, s64, v58
    s_waitcnt lgkmcnt(2)
    v_alignbit_b32 v32, v33, v32, v8
    v_lshrrev_b32 v33, v8, v33
    v_alignbit_b32 v48, v49, v48, v16
    v_lshrrev_b32 v49, v16, v49
    v_mul_f32 v56, v56, v56
    v_fmac_f32 v56, v57, v57
    v_fmac_f32 v56, v58, v58
    v_cmp_gt_f32 vcc, s45, v56
    s_and_b64 s[52:53], s[52:53], vcc
    v_lshlrev_b32 v59, 16, v32
    v_and_b32 v60, s44, v32
    v_lshlrev_b32 v61, 16, v33
    v_dot2_f32_bf16 v59, v48, s64, v59
    v_dot2_f32_bf16 v60, v48, s65, v60
    v_dot2_f32_bf16 v61, v49, s64, v61
    s_waitcnt lgkmcnt(0)
    v_alignbit_b32 v34, v35, v34, v9
    v_lshrrev_b32 v35, v9, v35
    v_alignbit_b32 v50, v51, v50, v17
    v_lshrrev_b32 v51, v17, v51
    v_mul_f32 v59, v59, v59
    v_fmac_f32 v59, v60, v60
    v_fmac_f32 v59, v61, v61
    v_cmp_gt_f32 vcc, s45, v59
    s_and_b64 s[54:55], s[54:55], vcc
    v_lshlrev_b32 v56, 16, v34
    v_and_b32 v57, s44, v34
    v_lshlrev_b32 v58, 16, v35
    v_dot2_f32_bf16 v56, v50, s64, v56
    v_dot2_f32_bf16 v57, v50, s65, v57
    v_dot2_f32_bf16 v58, v51, s64, v58
    s_nop 0
    v_mul_f32 v56, v56, v56
    v_fmac_f32 v56, v57, v57
    v_fmac_f32 v56, v58, v58
    v_cmp_gt_f32 vcc, s45, v56
    s_and_b64 s[56:57], s[56:57], vcc
    s_mov_b64 exec, s[46:47]
    ds_add_rtn_u32 v104, v80, v2
    s_mov_b64 exec, s[48:49]
    ds_add_rtn_u32 v105, v81, v2
    s_mov_b64 exec, s[50:51]
    ds_add_rtn_u32 v106, v82, v2
    s_mov_b64 exec, s[52:53]
    ds_add_rtn_u32 v107, v83, v2
    s_mov_b64 exec, s[54:55]
    ds_add_rtn_u32 v108, v84, v2
    s_mov_b64 exec, s[56:57]
    ds_add_rtn_u32 v109, v85, v2
    s_mov_b64 exec, s[58:59]
    ds_add_rtn_u32 v110, v86, v2
    s_mov_b64 exec, -1
    v_and_b32 v3, -4, v0
    v_mov_b32 v12, 1024
    v_lshrrev_b32 v13, 2, v0
    v_and_b32 v14, 3, v0
    v_lshlrev_b32 v1, 2, v14
    v_lshl_or_b32 v1, v13, 6, v1
    v_add_u32 v1, 2048, v1
    v_add_u32 v19, 8192, v1
    v_lshlrev_b32 v13, 13, v13
    v_lshl_or_b32 v13, v14, 4, v13
    s_lshl_b32 s3, s22, 6
    v_add_u32 v13, s3, v13
    s_mov_b64 s[60:61], 0
    s_waitcnt lgkmcnt(0)
    s_barrier
    v_cmp_gt_u32 vcc, 64, v104
    v_lshl_add_u32 v80, v80, 4, v104
    s_and_b64 exec, vcc, s[46:47]
    ds_write_b32 v80, v64 offset:2048
    s_andn2_b64 s[46:47], s[46:47], vcc
    s_or_b64 s[60:61], s[60:61], s[46:47]
    s_mov_b64 exec, -1
    v_cmp_gt_u32 vcc, 64, v105
    v_lshl_add_u32 v81, v81, 4, v105
    s_and_b64 exec, vcc, s[48:49]
    ds_write_b32 v81, v65 offset:2048
    s_andn2_b64 s[48:49], s[48:49], vcc
    s_or_b64 s[60:61], s[60:61], s[48:49]
    s_mov_b64 exec, -1
    v_cmp_gt_u32 vcc, 64, v106
    v_lshl_add_u32 v82, v82, 4, v106
    s_and_b64 exec, vcc, s[50:51]
    ds_write_b32 v82, v66 offset:2048
    s_andn2_b64 s[50:51], s[50:51], vcc
    s_or_b64 s[60:61], s[60:61], s[50:51]
    s_mov_b64 exec, -1
    v_cmp_gt_u32 vcc, 64, v107
    v_lshl_add_u32 v83, v83, 4, v107
    s_and_b64 exec, vcc, s[52:53]
    ds_write_b32 v83, v67 offset:2048
    s_andn2_b64 s[52:53], s[52:53], vcc
    s_or_b64 s[60:61], s[60:61], s[52:53]
    s_mov_b64 exec, -1
    v_cmp_gt_u32 vcc, 64, v108
    v_lshl_add_u32 v84, v84, 4, v108
    s_and_b64 exec, vcc, s[54:55]
    ds_write_b32 v84, v68 offset:2048
    s_andn2_b64 s[54:55], s[54:55], vcc
    s_or_b64 s[60:61], s[60:61], s[54:55]
    s_mov_b64 exec, -1
    v_cmp_gt_u32 vcc, 64, v109
    v_lshl_add_u32 v85, v85, 4, v109
    s_and_b64 exec, vcc, s[56:57]
    ds_write_b32 v85, v69 offset:2048
    s_andn2_b64 s[56:57], s[56:57], vcc
    s_or_b64 s[60:61], s[60:61], s[56:57]
    s_mov_b64 exec, -1
    v_cmp_gt_u32 vcc, 64, v110
    v_lshl_add_u32 v86, v86, 4, v110
    s_and_b64 exec, vcc, s[58:59]
    ds_write_b32 v86, v70 offset:2048
    s_andn2_b64 s[58:59], s[58:59], vcc
    s_or_b64 s[60:61], s[60:61], s[58:59]
    s_mov_b64 exec, -1
    s_cmp_eq_u64 s[60:61], 0
    s_cbranch_scc1 ka_e_noovf
    s_mul_i32 s3, s22, 12544
    s_mov_b64 exec, s[46:47]
    ds_add_rtn_u32 v57, v12, v2
    s_waitcnt lgkmcnt(0)
    v_add_u32 v57, s3, v57
    buffer_store_dword v64, v57, s[40:43], 0 offen
    s_mov_b64 exec, s[48:49]
    ds_add_rtn_u32 v57, v12, v2
    s_waitcnt lgkmcnt(0)
    v_add_u32 v57, s3, v57
    buffer_store_dword v65, v57, s[40:43], 0 offen
    s_mov_b64 exec, s[50:51]
    ds_add_rtn_u32 v57, v12, v2
    s_waitcnt lgkmcnt(0)
    v_add_u32 v57, s3, v57
    buffer_store_dword v66, v57, s[40:43], 0 offen
    s_mov_b64 exec, s[52:53]
    ds_add_rtn_u32 v57, v12, v2
    s_waitcnt lgkmcnt(0)
    v_add_u32 v57, s3, v57
    buffer_store_dword v67, v57, s[40:43], 0 offen
    s_mov_b64 exec, s[54:55]
    ds_add_rtn_u32 v57, v12, v2
    s_waitcnt lgkmcnt(0)
    v_add_u32 v57, s3, v57
    buffer_store_dword v68, v57, s[40:43], 0 offen
    s_mov_b64 exec, s[56:57]
    ds_add_rtn_u32 v57, v12, v2
    s_waitcnt lgkmcnt(0)
    v_add_u32 v57, s3, v57
    buffer_store_dword v69, v57, s[40:43], 0 offen
    s_mov_b64 exec, s[58:59]
    ds_add_rtn_u32 v57, v12, v2
    s_waitcnt lgkmcnt(0)
    v_add_u32 v57, s3, v57
    buffer_store_dword v70, v57, s[40:43], 0 offen
    s_mov_b64 exec, -1
ka_e_noovf:
    v_cmp_eq_u32 vcc, 0, v14
    s_mov_b32 s3, 1048576
    s_waitcnt lgkmcnt(0)
    s_barrier
    ds_read_b32 v16, v12
    ds_read2_b32 v[4:5], v1 offset1:4
    ds_read2_b32 v[6:7], v1 offset0:8 offset1:12
    ds_read_b32 v14, v3
    ds_read2_b32 v[8:9], v19 offset1:4
    ds_read2_b32 v[10:11], v19 offset0:8 offset1:12
    ds_read_b32 v15, v3 offset:512
    s_waitcnt lgkmcnt(3)
    v_lshl_or_b32 v14, v16, 14, v14
    v_cndmask_b32 v4, v4, v14, vcc
    buffer_store_dwordx4 v[4:7], v13, s[36:39], 0 offen
    s_waitcnt lgkmcnt(0)
    v_lshl_or_b32 v15, v16, 14, v15
    v_cndmask_b32 v8, v8, v15, vcc
    buffer_store_dwordx4 v[8:11], v13, s[36:39], s3 offen
    s_endpgm
ka_h:
    v_lshrrev_b32 v2, 4, v1
    v_and_b32 v3, 15, v1
    s_cmp_ge_u32 s22, 112
    s_cbranch_scc1 ka_prep
    v_lshlrev_b32 v4, 2, v2
    v_xor_b32 v4, v4, v3
    v_lshlrev_b32 v4, 4, v4
    v_lshl_or_b32 v4, v2, 8, v4
    s_and_b32 s24, s23, 3
    s_lshl_b32 s24, s24, 13
    s_and_b32 s42, s62, 7
    s_lshl_b32 s42, s42, 10
    s_lshl_b32 s26, s23, 5
    s_mul_i32 s27, s22, 224
    s_add_u32 s26, s26, s27
    s_lshl_b32 s25, s23, 13
    s_add_u32 s25, s25, 32768
    v_xor_b32 v7, v2, v3
    v_lshlrev_b32 v7, 4, v7
    v_add_u32 v8, s26, v2
    v_lshl_or_b32 v7, v8, 10, v7
    s_waitcnt lgkmcnt(0)
    s_mov_b32 s28, s14
    s_mov_b32 s29, s15
    s_mov_b32 s30, 32768
    s_mov_b32 s31, 0x00020000
    s_mov_b32 s32, s4
    s_mov_b32 s33, s5
    s_mov_b32 s34, 25600000
    s_mov_b32 s35, 0x00020000
    s_or_b32 s3, s24, s42
    s_cmp_lt_u32 s23, 4
    s_cbranch_scc1 ka_hs0
    s_add_u32 s42, s42, 1024
    s_and_b32 s42, s42, 0x1fff
    s_or_b32 s3, s24, s42
    s_mov_b32 m0, s3
    s_nop 0
    buffer_load_dwordx4 v4, s[28:31], s3 offen lds
    s_add_u32 s42, s42, 1024
    s_and_b32 s42, s42, 0x1fff
    s_or_b32 s3, s24, s42
    s_mov_b32 m0, s3
    s_nop 0
    buffer_load_dwordx4 v4, s[28:31], s3 offen lds
    s_add_u32 s42, s42, 1024
    s_and_b32 s42, s42, 0x1fff
    s_or_b32 s3, s24, s42
    s_mov_b32 m0, s3
    s_nop 0
    buffer_load_dwordx4 v4, s[28:31], s3 offen lds
    s_add_u32 s42, s42, 1024
    s_and_b32 s42, s42, 0x1fff
    s_or_b32 s3, s24, s42
    s_mov_b32 m0, s3
    s_nop 0
    buffer_load_dwordx4 v4, s[28:31], s3 offen lds
    s_add_u32 s42, s42, 1024
    s_and_b32 s42, s42, 0x1fff
    s_or_b32 s3, s24, s42
    s_mov_b32 m0, s3
    s_nop 0
    buffer_load_dwordx4 v4, s[28:31], s3 offen lds
    s_add_u32 s42, s42, 1024
    s_and_b32 s42, s42, 0x1fff
    s_or_b32 s3, s24, s42
    s_mov_b32 m0, s3
    s_nop 0
    buffer_load_dwordx4 v4, s[28:31], s3 offen lds
    s_add_u32 s42, s42, 1024
    s_and_b32 s42, s42, 0x1fff
    s_or_b32 s3, s24, s42
    s_mov_b32 m0, s3
    s_nop 0
    buffer_load_dwordx4 v4, s[28:31], s3 offen lds
    s_waitcnt vmcnt(0)
    s_barrier
    s_cmp_eq_u32 s23, 7
    s_cbranch_scc1 ka_pfexit
    s_branch ka_hs
ka_hs0:
    s_mov_b32 m0, s3
    s_nop 0
    buffer_load_dwordx4 v4, s[28:31], s3 offen lds
ka_hs:
    v_xor_b32 v16, 0, v7
    s_add_u32 m0, s25, 0
    s_movk_i32 s3, 0
    buffer_load_dwordx4 v16, s[32:35], s3 offen sc0 lds
    v_xor_b32 v17, 64, v7
    s_add_u32 m0, s25, 1024
    s_movk_i32 s3, 4096
    buffer_load_dwordx4 v17, s[32:35], s3 offen sc0 lds
    v_xor_b32 v18, 128, v7
    s_add_u32 m0, s25, 2048
    s_movk_i32 s3, 8192
    buffer_load_dwordx4 v18, s[32:35], s3 offen sc0 lds
    v_xor_b32 v19, 192, v7
    s_add_u32 m0, s25, 3072
    s_movk_i32 s3, 12288
    buffer_load_dwordx4 v19, s[32:35], s3 offen sc0 lds
    v_xor_b32 v20, 0, v7
    s_add_u32 m0, s25, 4096
    s_movk_i32 s3, 16384
    buffer_load_dwordx4 v20, s[32:35], s3 offen sc0 lds
    v_xor_b32 v21, 64, v7
    s_add_u32 m0, s25, 5120
    s_movk_i32 s3, 20480
    buffer_load_dwordx4 v21, s[32:35], s3 offen sc0 lds
    v_xor_b32 v22, 128, v7
    s_add_u32 m0, s25, 6144
    s_movk_i32 s3, 24576
    buffer_load_dwordx4 v22, s[32:35], s3 offen sc0 lds
    v_xor_b32 v23, 192, v7
    s_add_u32 m0, s25, 7168
    s_movk_i32 s3, 28672
    buffer_load_dwordx4 v23, s[32:35], s3 offen sc0 lds
    s_mov_b32 s36, s20
    s_mov_b32 s37, s21
    s_mov_b32 s38, 6400000
    s_mov_b32 s39, 0x00020000
    v_lshrrev_b32 v6, 5, v1
    v_bfe_u32 v8, v1, 2, 2
    v_and_b32 v9, 1, v1
    v_lshlrev_b32 v9, 5, v9
    v_and_b32 v10, 1, v2
    v_lshl_or_b32 v9, v10, 4, v9
    v_bfe_u32 v10, v1, 1, 1
    v_lshl_or_b32 v9, v10, 3, v9
    v_lshlrev_b32 v10, 6, v8
    v_xor_b32 v9, v9, v10
    v_lshl_add_u32 v10, v6, 3, v8
    v_lshl_or_b32 v11, v10, 8, v9
    v_xor_b32 v12, 64, v11
    v_xor_b32 v13, 0x80, v11
    v_xor_b32 v14, 0xc0, v11
    v_and_b32 v5, 31, v1
    v_xor_b32 v15, v6, v3
    v_lshlrev_b32 v15, 4, v15
    v_lshl_or_b32 v15, v5, 8, v15
    v_add_u32 v15, s25, v15
    v_add_u32 v5, s26, v5
    v_lshlrev_b32 v5, 8, v5
    v_lshl_or_b32 v5, v6, 5, v5
    s_mov_b32 s40, 0xbfb8aa3b
    s_mov_b32 s41, 0xbfb8aa3b
    s_cmp_ge_u32 s23, 4
    s_cbranch_scc1 ka_hnb
    s_waitcnt vmcnt(8)
    s_barrier
ka_hnb:
    ds_read_b64_tr_b16 v[48:49], v11 offset:0
    ds_read_b64_tr_b16 v[50:51], v11 offset:1024
    ds_read_b64_tr_b16 v[52:53], v11 offset:4096
    ds_read_b64_tr_b16 v[54:55], v11 offset:5120
    ds_read_b64_tr_b16 v[56:57], v11 offset:8192
    ds_read_b64_tr_b16 v[58:59], v11 offset:9216
    s_waitcnt vmcnt(0)
    ds_read_b128 v[16:19], v15
    v_xor_b32 v113, 32, v15
    ds_read_b128 v[20:23], v113
    v_xor_b32 v114, 64, v15
    ds_read_b128 v[24:27], v114
    v_xor_b32 v115, 96, v15
    ds_read_b128 v[28:31], v115
    v_xor_b32 v116, 128, v15
    ds_read_b128 v[32:35], v116
    v_xor_b32 v117, 160, v15
    ds_read_b128 v[36:39], v117
    v_xor_b32 v118, 192, v15
    ds_read_b128 v[40:43], v118
    v_xor_b32 v119, 224, v15
    ds_read_b128 v[44:47], v119
    s_waitcnt lgkmcnt(7)
    v_mfma_f32_32x32x16_bf16 v[80:95], v[48:51], v[16:19], 0
    ds_read_b64_tr_b16 v[60:61], v11 offset:12288
    ds_read_b64_tr_b16 v[62:63], v11 offset:13312
    ds_read_b64_tr_b16 v[64:65], v11 offset:16384
    ds_read_b64_tr_b16 v[66:67], v11 offset:17408
    ds_read_b64_tr_b16 v[68:69], v11 offset:20480
    ds_read_b64_tr_b16 v[70:71], v11 offset:21504
    ds_read_b64_tr_b16 v[72:73], v11 offset:24576
    ds_read_b64_tr_b16 v[74:75], v11 offset:25600
    s_waitcnt lgkmcnt(14)
    v_mfma_f32_32x32x16_bf16 v[80:95], v[52:55], v[20:23], v[80:95]
    s_waitcnt lgkmcnt(13)
    v_mfma_f32_32x32x16_bf16 v[80:95], v[56:59], v[24:27], v[80:95]
    ds_read_b64_tr_b16 v[76:77], v11 offset:28672
    ds_read_b64_tr_b16 v[78:79], v11 offset:29696
    s_waitcnt lgkmcnt(8)
    v_mfma_f32_32x32x16_bf16 v[80:95], v[60:63], v[28:31], v[80:95]
    ds_read_b64_tr_b16 v[48:49], v12 offset:0
    ds_read_b64_tr_b16 v[50:51], v12 offset:1024
    ds_read_b64_tr_b16 v[52:53], v12 offset:4096
    ds_read_b64_tr_b16 v[54:55], v12 offset:5120
    s_waitcnt lgkmcnt(10)
    v_mfma_f32_32x32x16_bf16 v[80:95], v[64:67], v[32:35], v[80:95]
    ds_read_b64_tr_b16 v[56:57], v12 offset:8192
    ds_read_b64_tr_b16 v[58:59], v12 offset:9216
    s_waitcnt lgkmcnt(10)
    v_mfma_f32_32x32x16_bf16 v[80:95], v[68:71], v[36:39], v[80:95]
    ds_read_b64_tr_b16 v[60:61], v12 offset:12288
    ds_read_b64_tr_b16 v[62:63], v12 offset:13312
    s_waitcnt lgkmcnt(10)
    v_mfma_f32_32x32x16_bf16 v[80:95], v[72:75], v[40:43], v[80:95]
    ds_read_b64_tr_b16 v[64:65], v12 offset:16384
    ds_read_b64_tr_b16 v[66:67], v12 offset:17408
    s_waitcnt lgkmcnt(10)
    v_mfma_f32_32x32x16_bf16 v[80:95], v[76:79], v[44:47], v[80:95]
    ds_read_b64_tr_b16 v[68:69], v12 offset:20480
    ds_read_b64_tr_b16 v[70:71], v12 offset:21504
    s_waitcnt lgkmcnt(10)
    v_mfma_f32_32x32x16_bf16 v[96:111], v[48:51], v[16:19], 0
    ds_read_b64_tr_b16 v[72:73], v12 offset:24576
    ds_read_b64_tr_b16 v[74:75], v12 offset:25600
    s_waitcnt lgkmcnt(10)
    v_mfma_f32_32x32x16_bf16 v[96:111], v[52:55], v[20:23], v[96:111]
    s_nop 3
    v_mul_f32 v112, s40, v80
    v_mul_f32 v113, s40, v81
    v_mul_f32 v114, s40, v82
    v_mul_f32 v115, s40, v83
    v_mul_f32 v116, s40, v84
    v_mul_f32 v117, s40, v85
    v_mul_f32 v118, s40, v86
    v_mul_f32 v119, s40, v87
    v_exp_f32 v112, v112
    v_exp_f32 v113, v113
    v_exp_f32 v114, v114
    v_exp_f32 v115, v115
    v_exp_f32 v116, v116
    ds_read_b64_tr_b16 v[76:77], v12 offset:28672
    ds_read_b64_tr_b16 v[78:79], v12 offset:29696
    s_waitcnt lgkmcnt(10)
    v_mfma_f32_32x32x16_bf16 v[96:111], v[56:59], v[24:27], v[96:111]
    v_exp_f32 v117, v117
    v_exp_f32 v118, v118
    v_exp_f32 v119, v119
    v_add_f32 v112, 1.0, v112
    v_add_f32 v113, 1.0, v113
    v_add_f32 v114, 1.0, v114
    v_add_f32 v115, 1.0, v115
    v_add_f32 v116, 1.0, v116
    v_add_f32 v117, 1.0, v117
    v_add_f32 v118, 1.0, v118
    v_add_f32 v119, 1.0, v119
    v_rcp_f32 v112, v112
    v_rcp_f32 v113, v113
    ds_read_b64_tr_b16 v[48:49], v13 offset:0
    ds_read_b64_tr_b16 v[50:51], v13 offset:1024
    s_waitcnt lgkmcnt(10)
    v_mfma_f32_32x32x16_bf16 v[96:111], v[60:63], v[28:31], v[96:111]
    v_rcp_f32 v114, v114
    v_rcp_f32 v115, v115
    v_rcp_f32 v116, v116
    v_rcp_f32 v117, v117
    v_rcp_f32 v118, v118
    v_rcp_f32 v119, v119
    v_mul_f32 v112, v112, v80
    v_mul_f32 v113, v113, v81
    v_mul_f32 v114, v114, v82
    v_mul_f32 v115, v115, v83
    v_mul_f32 v116, v116, v84
    v_mul_f32 v117, v117, v85
    v_mul_f32 v118, v118, v86
    ds_read_b64_tr_b16 v[52:53], v13 offset:4096
    ds_read_b64_tr_b16 v[54:55], v13 offset:5120
    s_waitcnt lgkmcnt(10)
    v_mfma_f32_32x32x16_bf16 v[96:111], v[64:67], v[32:35], v[96:111]
    v_mul_f32 v119, v119, v87
    v_cvt_pk_bf16_f32 v128, v112, v113
    v_cvt_pk_bf16_f32 v129, v114, v115
    v_cvt_pk_bf16_f32 v130, v116, v117
    v_cvt_pk_bf16_f32 v131, v118, v119
    buffer_store_dwordx4 v[128:131], v5, s[36:39], 0 offen offset:0
    v_mul_f32 v120, s40, v88
    v_mul_f32 v121, s40, v89
    v_mul_f32 v122, s40, v90
    v_mul_f32 v123, s40, v91
    v_mul_f32 v124, s40, v92
    v_mul_f32 v125, s40, v93
    v_mul_f32 v126, s40, v94
    ds_read_b64_tr_b16 v[56:57], v13 offset:8192
    ds_read_b64_tr_b16 v[58:59], v13 offset:9216
    s_waitcnt lgkmcnt(10)
    v_mfma_f32_32x32x16_bf16 v[96:111], v[68:71], v[36:39], v[96:111]
    v_mul_f32 v127, s40, v95
    v_exp_f32 v120, v120
    v_exp_f32 v121, v121
    v_exp_f32 v122, v122
    v_exp_f32 v123, v123
    v_exp_f32 v124, v124
    v_exp_f32 v125, v125
    v_exp_f32 v126, v126
    v_exp_f32 v127, v127
    v_add_f32 v120, 1.0, v120
    v_add_f32 v121, 1.0, v121
    v_add_f32 v122, 1.0, v122
    v_add_f32 v123, 1.0, v123
    ds_read_b64_tr_b16 v[60:61], v13 offset:12288
    ds_read_b64_tr_b16 v[62:63], v13 offset:13312
    s_waitcnt lgkmcnt(10)
    v_mfma_f32_32x32x16_bf16 v[96:111], v[72:75], v[40:43], v[96:111]
    v_add_f32 v124, 1.0, v124
    v_add_f32 v125, 1.0, v125
    v_add_f32 v126, 1.0, v126
    v_add_f32 v127, 1.0, v127
    v_rcp_f32 v120, v120
    v_rcp_f32 v121, v121
    v_rcp_f32 v122, v122
    v_rcp_f32 v123, v123
    v_rcp_f32 v124, v124
    v_rcp_f32 v125, v125
    v_rcp_f32 v126, v126
    v_rcp_f32 v127, v127
    v_mul_f32 v120, v120, v88
    ds_read_b64_tr_b16 v[64:65], v13 offset:16384
    ds_read_b64_tr_b16 v[66:67], v13 offset:17408
    s_waitcnt lgkmcnt(10)
    v_mfma_f32_32x32x16_bf16 v[96:111], v[76:79], v[44:47], v[96:111]
    v_mul_f32 v121, v121, v89
    v_mul_f32 v122, v122, v90
    v_mul_f32 v123, v123, v91
    v_mul_f32 v124, v124, v92
    v_mul_f32 v125, v125, v93
    v_mul_f32 v126, v126, v94
    v_mul_f32 v127, v127, v95
    v_cvt_pk_bf16_f32 v132, v120, v121
    v_cvt_pk_bf16_f32 v133, v122, v123
    v_cvt_pk_bf16_f32 v134, v124, v125
    v_cvt_pk_bf16_f32 v135, v126, v127
    buffer_store_dwordx4 v[132:135], v5, s[36:39], 0 offen offset:16
    ds_read_b64_tr_b16 v[68:69], v13 offset:20480
    ds_read_b64_tr_b16 v[70:71], v13 offset:21504
    s_waitcnt lgkmcnt(10)
    v_mfma_f32_32x32x16_bf16 v[80:95], v[48:51], v[16:19], 0
    ds_read_b64_tr_b16 v[72:73], v13 offset:24576
    ds_read_b64_tr_b16 v[74:75], v13 offset:25600
    s_waitcnt lgkmcnt(10)
    v_mfma_f32_32x32x16_bf16 v[80:95], v[52:55], v[20:23], v[80:95]
    v_mul_f32 v112, s40, v96
    v_mul_f32 v113, s40, v97
    v_mul_f32 v114, s40, v98
    v_mul_f32 v115, s40, v99
    v_mul_f32 v116, s40, v100
    v_mul_f32 v117, s40, v101
    v_mul_f32 v118, s40, v102
    v_mul_f32 v119, s40, v103
    v_exp_f32 v112, v112
    v_exp_f32 v113, v113
    v_exp_f32 v114, v114
    v_exp_f32 v115, v115
    v_exp_f32 v116, v116
    ds_read_b64_tr_b16 v[76:77], v13 offset:28672
    ds_read_b64_tr_b16 v[78:79], v13 offset:29696
    s_waitcnt lgkmcnt(10)
    v_mfma_f32_32x32x16_bf16 v[80:95], v[56:59], v[24:27], v[80:95]
    v_exp_f32 v117, v117
    v_exp_f32 v118, v118
    v_exp_f32 v119, v119
    v_add_f32 v112, 1.0, v112
    v_add_f32 v113, 1.0, v113
    v_add_f32 v114, 1.0, v114
    v_add_f32 v115, 1.0, v115
    v_add_f32 v116, 1.0, v116
    v_add_f32 v117, 1.0, v117
    v_add_f32 v118, 1.0, v118
    v_add_f32 v119, 1.0, v119
    v_rcp_f32 v112, v112
    v_rcp_f32 v113, v113
    ds_read_b64_tr_b16 v[48:49], v14 offset:0
    ds_read_b64_tr_b16 v[50:51], v14 offset:1024
    s_waitcnt lgkmcnt(10)
    v_mfma_f32_32x32x16_bf16 v[80:95], v[60:63], v[28:31], v[80:95]
    v_rcp_f32 v114, v114
    v_rcp_f32 v115, v115
    v_rcp_f32 v116, v116
    v_rcp_f32 v117, v117
    v_rcp_f32 v118, v118
    v_rcp_f32 v119, v119
    v_mul_f32 v112, v112, v96
    v_mul_f32 v113, v113, v97
    v_mul_f32 v114, v114, v98
    v_mul_f32 v115, v115, v99
    v_mul_f32 v116, v116, v100
    v_mul_f32 v117, v117, v101
    v_mul_f32 v118, v118, v102
    ds_read_b64_tr_b16 v[52:53], v14 offset:4096
    ds_read_b64_tr_b16 v[54:55], v14 offset:5120
    s_waitcnt lgkmcnt(10)
    v_mfma_f32_32x32x16_bf16 v[80:95], v[64:67], v[32:35], v[80:95]
    v_mul_f32 v119, v119, v103
    v_cvt_pk_bf16_f32 v136, v112, v113
    v_cvt_pk_bf16_f32 v137, v114, v115
    v_cvt_pk_bf16_f32 v138, v116, v117
    v_cvt_pk_bf16_f32 v139, v118, v119
    buffer_store_dwordx4 v[136:139], v5, s[36:39], 0 offen offset:64
    v_mul_f32 v120, s40, v104
    v_mul_f32 v121, s40, v105
    v_mul_f32 v122, s40, v106
    v_mul_f32 v123, s40, v107
    v_mul_f32 v124, s40, v108
    v_mul_f32 v125, s40, v109
    v_mul_f32 v126, s40, v110
    ds_read_b64_tr_b16 v[56:57], v14 offset:8192
    ds_read_b64_tr_b16 v[58:59], v14 offset:9216
    s_waitcnt lgkmcnt(10)
    v_mfma_f32_32x32x16_bf16 v[80:95], v[68:71], v[36:39], v[80:95]
    v_mul_f32 v127, s40, v111
    v_exp_f32 v120, v120
    v_exp_f32 v121, v121
    v_exp_f32 v122, v122
    v_exp_f32 v123, v123
    v_exp_f32 v124, v124
    v_exp_f32 v125, v125
    v_exp_f32 v126, v126
    v_exp_f32 v127, v127
    v_add_f32 v120, 1.0, v120
    v_add_f32 v121, 1.0, v121
    v_add_f32 v122, 1.0, v122
    v_add_f32 v123, 1.0, v123
    ds_read_b64_tr_b16 v[60:61], v14 offset:12288
    ds_read_b64_tr_b16 v[62:63], v14 offset:13312
    s_waitcnt lgkmcnt(10)
    v_mfma_f32_32x32x16_bf16 v[80:95], v[72:75], v[40:43], v[80:95]
    v_add_f32 v124, 1.0, v124
    v_add_f32 v125, 1.0, v125
    v_add_f32 v126, 1.0, v126
    v_add_f32 v127, 1.0, v127
    v_rcp_f32 v120, v120
    v_rcp_f32 v121, v121
    v_rcp_f32 v122, v122
    v_rcp_f32 v123, v123
    v_rcp_f32 v124, v124
    v_rcp_f32 v125, v125
    v_rcp_f32 v126, v126
    v_rcp_f32 v127, v127
    v_mul_f32 v120, v120, v104
    ds_read_b64_tr_b16 v[64:65], v14 offset:16384
    ds_read_b64_tr_b16 v[66:67], v14 offset:17408
    s_waitcnt lgkmcnt(10)
    v_mfma_f32_32x32x16_bf16 v[80:95], v[76:79], v[44:47], v[80:95]
    v_mul_f32 v121, v121, v105
    v_mul_f32 v122, v122, v106
    v_mul_f32 v123, v123, v107
    v_mul_f32 v124, v124, v108
    v_mul_f32 v125, v125, v109
    v_mul_f32 v126, v126, v110
    v_mul_f32 v127, v127, v111
    v_cvt_pk_bf16_f32 v140, v120, v121
    v_cvt_pk_bf16_f32 v141, v122, v123
    v_cvt_pk_bf16_f32 v142, v124, v125
    v_cvt_pk_bf16_f32 v143, v126, v127
    buffer_store_dwordx4 v[140:143], v5, s[36:39], 0 offen offset:80
    ds_read_b64_tr_b16 v[68:69], v14 offset:20480
    ds_read_b64_tr_b16 v[70:71], v14 offset:21504
    s_waitcnt lgkmcnt(10)
    v_mfma_f32_32x32x16_bf16 v[96:111], v[48:51], v[16:19], 0
    ds_read_b64_tr_b16 v[72:73], v14 offset:24576
    ds_read_b64_tr_b16 v[74:75], v14 offset:25600
    s_waitcnt lgkmcnt(10)
    v_mfma_f32_32x32x16_bf16 v[96:111], v[52:55], v[20:23], v[96:111]
    v_mul_f32 v112, s40, v80
    v_mul_f32 v113, s40, v81
    v_mul_f32 v114, s40, v82
    v_mul_f32 v115, s40, v83
    v_mul_f32 v116, s40, v84
    v_mul_f32 v117, s40, v85
    v_mul_f32 v118, s40, v86
    v_mul_f32 v119, s40, v87
    v_exp_f32 v112, v112
    v_exp_f32 v113, v113
    v_exp_f32 v114, v114
    v_exp_f32 v115, v115
    v_exp_f32 v116, v116
    ds_read_b64_tr_b16 v[76:77], v14 offset:28672
    ds_read_b64_tr_b16 v[78:79], v14 offset:29696
    s_waitcnt lgkmcnt(10)
    v_mfma_f32_32x32x16_bf16 v[96:111], v[56:59], v[24:27], v[96:111]
    v_exp_f32 v117, v117
    v_exp_f32 v118, v118
    v_exp_f32 v119, v119
    v_add_f32 v112, 1.0, v112
    v_add_f32 v113, 1.0, v113
    v_add_f32 v114, 1.0, v114
    v_add_f32 v115, 1.0, v115
    v_add_f32 v116, 1.0, v116
    v_add_f32 v117, 1.0, v117
    v_add_f32 v118, 1.0, v118
    v_add_f32 v119, 1.0, v119
    v_rcp_f32 v112, v112
    v_rcp_f32 v113, v113
    s_waitcnt lgkmcnt(8)
    v_mfma_f32_32x32x16_bf16 v[96:111], v[60:63], v[28:31], v[96:111]
    v_rcp_f32 v114, v114
    v_rcp_f32 v115, v115
    v_rcp_f32 v116, v116
    v_rcp_f32 v117, v117
    v_rcp_f32 v118, v118
    v_rcp_f32 v119, v119
    v_mul_f32 v112, v112, v80
    v_mul_f32 v113, v113, v81
    v_mul_f32 v114, v114, v82
    v_mul_f32 v115, v115, v83
    v_mul_f32 v116, v116, v84
    v_mul_f32 v117, v117, v85
    v_mul_f32 v118, v118, v86
    s_waitcnt lgkmcnt(6)
    v_mfma_f32_32x32x16_bf16 v[96:111], v[64:67], v[32:35], v[96:111]
    v_mul_f32 v119, v119, v87
    v_cvt_pk_bf16_f32 v128, v112, v113
    v_cvt_pk_bf16_f32 v129, v114, v115
    v_cvt_pk_bf16_f32 v130, v116, v117
    v_cvt_pk_bf16_f32 v131, v118, v119
    buffer_store_dwordx4 v[128:131], v5, s[36:39], 0 offen offset:128
    v_mul_f32 v120, s40, v88
    v_mul_f32 v121, s40, v89
    v_mul_f32 v122, s40, v90
    v_mul_f32 v123, s40, v91
    v_mul_f32 v124, s40, v92
    v_mul_f32 v125, s40, v93
    v_mul_f32 v126, s40, v94
    s_waitcnt lgkmcnt(4)
    v_mfma_f32_32x32x16_bf16 v[96:111], v[68:71], v[36:39], v[96:111]
    v_mul_f32 v127, s40, v95
    v_exp_f32 v120, v120
    v_exp_f32 v121, v121
    v_exp_f32 v122, v122
    v_exp_f32 v123, v123
    v_exp_f32 v124, v124
    v_exp_f32 v125, v125
    v_exp_f32 v126, v126
    v_exp_f32 v127, v127
    v_add_f32 v120, 1.0, v120
    v_add_f32 v121, 1.0, v121
    v_add_f32 v122, 1.0, v122
    v_add_f32 v123, 1.0, v123
    s_waitcnt lgkmcnt(2)
    v_mfma_f32_32x32x16_bf16 v[96:111], v[72:75], v[40:43], v[96:111]
    v_add_f32 v124, 1.0, v124
    v_add_f32 v125, 1.0, v125
    v_add_f32 v126, 1.0, v126
    v_add_f32 v127, 1.0, v127
    v_rcp_f32 v120, v120
    v_rcp_f32 v121, v121
    v_rcp_f32 v122, v122
    v_rcp_f32 v123, v123
    v_rcp_f32 v124, v124
    v_rcp_f32 v125, v125
    v_rcp_f32 v126, v126
    v_rcp_f32 v127, v127
    v_mul_f32 v120, v120, v88
    s_waitcnt lgkmcnt(0)
    v_mfma_f32_32x32x16_bf16 v[96:111], v[76:79], v[44:47], v[96:111]
    v_mul_f32 v121, v121, v89
    v_mul_f32 v122, v122, v90
    v_mul_f32 v123, v123, v91
    v_mul_f32 v124, v124, v92
    v_mul_f32 v125, v125, v93
    v_mul_f32 v126, v126, v94
    v_mul_f32 v127, v127, v95
    v_cvt_pk_bf16_f32 v132, v120, v121
    v_cvt_pk_bf16_f32 v133, v122, v123
    v_cvt_pk_bf16_f32 v134, v124, v125
    v_cvt_pk_bf16_f32 v135, v126, v127
    buffer_store_dwordx4 v[132:135], v5, s[36:39], 0 offen offset:144
    v_mul_f32 v112, s40, v96
    v_mul_f32 v113, s40, v97
    v_mul_f32 v114, s40, v98
    v_mul_f32 v115, s40, v99
    v_mul_f32 v116, s40, v100
    v_mul_f32 v117, s40, v101
    v_mul_f32 v118, s40, v102
    v_mul_f32 v119, s40, v103
    v_exp_f32 v112, v112
    v_exp_f32 v113, v113
    v_exp_f32 v114, v114
    v_exp_f32 v115, v115
    v_exp_f32 v116, v116
    v_exp_f32 v117, v117
    v_exp_f32 v118, v118
    v_exp_f32 v119, v119
    v_add_f32 v112, 1.0, v112
    v_add_f32 v113, 1.0, v113
    v_add_f32 v114, 1.0, v114
    v_add_f32 v115, 1.0, v115
    v_add_f32 v116, 1.0, v116
    v_add_f32 v117, 1.0, v117
    v_add_f32 v118, 1.0, v118
    v_add_f32 v119, 1.0, v119
    v_rcp_f32 v112, v112
    v_rcp_f32 v113, v113
    v_rcp_f32 v114, v114
    v_rcp_f32 v115, v115
    v_rcp_f32 v116, v116
    v_rcp_f32 v117, v117
    v_rcp_f32 v118, v118
    v_rcp_f32 v119, v119
    v_mul_f32 v112, v112, v96
    v_mul_f32 v113, v113, v97
    v_mul_f32 v114, v114, v98
    v_mul_f32 v115, v115, v99
    v_mul_f32 v116, v116, v100
    v_mul_f32 v117, v117, v101
    v_mul_f32 v118, v118, v102
    v_mul_f32 v119, v119, v103
    v_cvt_pk_bf16_f32 v136, v112, v113
    v_cvt_pk_bf16_f32 v137, v114, v115
    v_cvt_pk_bf16_f32 v138, v116, v117
    v_cvt_pk_bf16_f32 v139, v118, v119
    buffer_store_dwordx4 v[136:139], v5, s[36:39], 0 offen offset:192
    v_mul_f32 v120, s40, v104
    v_mul_f32 v121, s40, v105
    v_mul_f32 v122, s40, v106
    v_mul_f32 v123, s40, v107
    v_mul_f32 v124, s40, v108
    v_mul_f32 v125, s40, v109
    v_mul_f32 v126, s40, v110
    v_mul_f32 v127, s40, v111
    v_exp_f32 v120, v120
    v_exp_f32 v121, v121
    v_exp_f32 v122, v122
    v_exp_f32 v123, v123
    v_exp_f32 v124, v124
    v_exp_f32 v125, v125
    v_exp_f32 v126, v126
    v_exp_f32 v127, v127
    v_add_f32 v120, 1.0, v120
    v_add_f32 v121, 1.0, v121
    v_add_f32 v122, 1.0, v122
    v_add_f32 v123, 1.0, v123
    v_add_f32 v124, 1.0, v124
    v_add_f32 v125, 1.0, v125
    v_add_f32 v126, 1.0, v126
    v_add_f32 v127, 1.0, v127
    v_rcp_f32 v120, v120
    v_rcp_f32 v121, v121
    v_rcp_f32 v122, v122
    v_rcp_f32 v123, v123
    v_rcp_f32 v124, v124
    v_rcp_f32 v125, v125
    v_rcp_f32 v126, v126
    v_rcp_f32 v127, v127
    v_mul_f32 v120, v120, v104
    v_mul_f32 v121, v121, v105
    v_mul_f32 v122, v122, v106
    v_mul_f32 v123, v123, v107
    v_mul_f32 v124, v124, v108
    v_mul_f32 v125, v125, v109
    v_mul_f32 v126, v126, v110
    v_mul_f32 v127, v127, v111
    v_cvt_pk_bf16_f32 v140, v120, v121
    v_cvt_pk_bf16_f32 v141, v122, v123
    v_cvt_pk_bf16_f32 v142, v124, v125
    v_cvt_pk_bf16_f32 v143, v126, v127
    buffer_store_dwordx4 v[140:143], v5, s[36:39], 0 offen offset:208
    s_endpgm
ka_prep:
    s_sub_u32 s24, s22, 112
    s_lshl_b32 s24, s24, 3
    s_add_u32 s24, s24, s23
    s_waitcnt lgkmcnt(0)
    s_cmp_ge_u32 s24, 120
    s_cbranch_scc1 ka_pfexit
    s_cmp_ge_u32 s24, 96
    s_cbranch_scc1 ka_prep_wr
    s_lshr_b32 s25, s24, 2
    s_and_b32 s26, s24, 3
    s_mul_i32 s27, s25, 0x5556
    s_lshr_b32 s27, s27, 16
    s_mul_i32 s3, s27, 3
    s_sub_u32 s3, s25, s3
    s_lshl_b32 s27, s27, 5
    s_lshl_b32 s3, s3, 8
    s_add_u32 s27, s27, s3
    s_mul_i32 s26, s26, 24576
    s_add_u32 s27, s27, s26
    v_mul_u32_u24 v4, 6144, v2
    v_lshl_add_u32 v4, v3, 1, v4
    v_add_u32 v4, s27, v4
    s_lshl_b32 s3, s24, 10
    v_lshlrev_b32 v5, 4, v1
    v_add_u32 v5, s3, v5
    v_add_u32 v6, 3072, v4
    s_mov_b32 s40, s16
    s_mov_b32 s41, s17
    s_mov_b32 s42, 98304
    s_mov_b32 s43, 0x00020000
    s_add_u32 s44, s20, 6553600
    s_addc_u32 s45, s21, 0
    s_mov_b32 s46, 98304
    s_mov_b32 s47, 0x00020000
    buffer_load_ushort v12, v4, s[40:43], 0 offen offset:0
    buffer_load_ushort v13, v4, s[40:43], 0 offen offset:768
    buffer_load_ushort v14, v4, s[40:43], 0 offen offset:1536
    buffer_load_ushort v15, v4, s[40:43], 0 offen offset:2304
    buffer_load_ushort v16, v6, s[40:43], 0 offen offset:0
    buffer_load_ushort v17, v6, s[40:43], 0 offen offset:768
    buffer_load_ushort v18, v6, s[40:43], 0 offen offset:1536
    buffer_load_ushort v19, v6, s[40:43], 0 offen offset:2304
    s_waitcnt vmcnt(0)
    v_lshl_or_b32 v8, v13, 16, v12
    v_lshl_or_b32 v9, v15, 16, v14
    v_lshl_or_b32 v10, v17, 16, v16
    v_lshl_or_b32 v11, v19, 16, v18
    buffer_store_dwordx4 v[8:11], v5, s[44:47], 0 offen
    s_branch ka_pfexit
ka_prep_wr:
    s_sub_u32 s25, s24, 96
    s_mul_i32 s27, s25, 0x5556
    s_lshr_b32 s27, s27, 16
    s_mul_i32 s3, s27, 3
    s_sub_u32 s3, s25, s3
    s_lshl_b32 s27, s27, 5
    s_lshl_b32 s3, s3, 8
    s_add_u32 s27, s27, s3
    v_mul_u32_u24 v4, 3072, v2
    v_lshl_add_u32 v4, v3, 1, v4
    v_add_u32 v4, s27, v4
    s_lshl_b32 s3, s25, 9
    v_lshlrev_b32 v5, 3, v1
    v_add_u32 v5, s3, v5
    s_mov_b32 s40, s18
    s_mov_b32 s41, s19
    s_mov_b32 s42, 12288
    s_mov_b32 s43, 0x00020000
    s_add_u32 s44, s20, 6684672
    s_addc_u32 s45, s21, 0
    s_mov_b32 s46, 12288
    s_mov_b32 s47, 0x00020000
    buffer_load_ushort v12, v4, s[40:43], 0 offen offset:0
    buffer_load_ushort v13, v4, s[40:43], 0 offen offset:768
    buffer_load_ushort v14, v4, s[40:43], 0 offen offset:1536
    buffer_load_ushort v15, v4, s[40:43], 0 offen offset:2304
    s_waitcnt vmcnt(0)
    v_lshl_or_b32 v8, v13, 16, v12
    v_lshl_or_b32 v9, v15, 16, v14
    buffer_store_dwordx2 v[8:9], v5, s[44:47], 0 offen
ka_pfexit:
ka_exit:
    s_endpgm
.globl kb_kernel
.p2align 8
.type kb_kernel,@function
kb_kernel:
    s_cmp_ge_u32 s2, 256
    s_cbranch_scc1 kb_exit
    s_load_dwordx2 s[24:25], s[0:1], 80
    s_load_dwordx4 s[4:7], s[0:1], 0
    s_load_dwordx2 s[20:21], s[0:1], 64
    s_load_dwordx2 s[12:13], s[0:1], 32
    v_lshrrev_b32 v139, 6, v0
    s_nop 0
    v_readfirstlane_b32 s52, v139
    s_lshl_b32 s59, s2, 13
    s_add_u32 s59, s59, 262144
    v_lshl_add_u32 v140, v0, 4, s59
    s_mul_i32 s54, s2, 98
    s_mov_b32 s63, 0
    s_waitcnt lgkmcnt(0)
    s_add_u32 s44, s24, 6553600
    s_addc_u32 s45, s25, 0
    s_mov_b32 s46, 5537792
    s_mov_b32 s47, 0x00020000
    buffer_load_dwordx4 v[204:207], v140, s[44:47], 0 offen
    v_and_b32 v136, 63, v0
    v_lshlrev_b32 v211, 4, v136
    v_lshlrev_b32 v212, 3, v136
    s_mul_i32 s16, s52, 12288
    s_mul_i32 s61, s52, 1536
    s_add_u32 s61, s61, 131072
    s_mov_b32 s48, s4
    s_mov_b32 s49, s5
    s_mov_b32 s50, 25600000
    s_mov_b32 s51, 0x00020000
    s_mov_b32 s28, s4
    s_mov_b32 s29, s5
    s_mov_b32 s30, 25600000
    s_mov_b32 s31, 0x00020000
    s_mov_b32 s32, s20
    s_mov_b32 s33, s21
    s_mov_b32 s34, 25600000
    s_mov_b32 s35, 0x00020000
    s_mov_b32 s36, s24
    s_mov_b32 s37, s25
    s_mov_b32 s38, 6400000
    s_mov_b32 s39, 0x00020000
    s_mov_b32 s40, s6
    s_mov_b32 s41, s7
    s_mov_b32 s42, 150000
    s_mov_b32 s43, 0x00020000
    v_and_b32 v144, 7, v0
    v_lshlrev_b32 v144, 2, v144
    v_add_u32 v144, 135680, v144
    v_mov_b32 v145, 0
    ds_write_b32 v144, v145
    s_waitcnt lgkmcnt(0)
    s_barrier
    s_load_dwordx8 s[64:71], s[12:13], 0
    s_bitcmp1_b32 s2, 3
    s_cbranch_scc1 kb_wb0_1
    s_add_u32 s60, s16, 0
    buffer_load_dwordx4 v[20:23], v211, s[44:47], s60 offen offset:0
    buffer_load_dwordx4 v[24:27], v211, s[44:47], s60 offen offset:1024
    buffer_load_dwordx4 v[28:31], v211, s[44:47], s60 offen offset:2048
    buffer_load_dwordx4 v[32:35], v211, s[44:47], s60 offen offset:3072
    s_add_u32 s60, s60, 4096
    buffer_load_dwordx4 v[36:39], v211, s[44:47], s60 offen offset:0
    buffer_load_dwordx4 v[40:43], v211, s[44:47], s60 offen offset:1024
    s_branch kb_wb0_e
kb_wb0_1:
    s_add_u32 s60, s16, 6144
    buffer_load_dwordx4 v[44:47], v211, s[44:47], s60 offen offset:0
    buffer_load_dwordx4 v[48:51], v211, s[44:47], s60 offen offset:1024
    buffer_load_dwordx4 v[52:55], v211, s[44:47], s60 offen offset:2048
    buffer_load_dwordx4 v[56:59], v211, s[44:47], s60 offen offset:3072
    s_add_u32 s60, s60, 4096
    buffer_load_dwordx4 v[60:63], v211, s[44:47], s60 offen offset:0
    buffer_load_dwordx4 v[64:67], v211, s[44:47], s60 offen offset:1024
kb_wb0_e:
    buffer_load_dwordx2 v[68:69], v212, s[44:47], s61 offen offset:0
    buffer_load_dwordx2 v[70:71], v212, s[44:47], s61 offen offset:512
    buffer_load_dwordx2 v[72:73], v212, s[44:47], s61 offen offset:1024
    v_and_b32 v137, 15, v0
    v_bfe_u32 v138, v0, 4, 2
    v_bfe_u32 v146, v0, 3, 3
    v_lshlrev_b32 v146, 8, v146
    v_and_b32 v147, 7, v0
    v_lshl_or_b32 v146, v147, 4, v146
    s_and_b32 s61, s52, 3
    s_lshl_b32 s62, s61, 2
    s_add_u32 s62, s62, s54
    s_lshl_b32 s62, s62, 10
    s_lshr_b32 s60, s52, 2
    s_lshl_b32 s18, s60, 7
    s_add_u32 s62, s62, s18
    v_add_u32 v8, s62, v146
    s_cmp_eq_u32 s61, 3
    s_cselect_b32 s62, 0x40000000, 0
    v_add_u32 v236, s62, v8
    s_mul_i32 s60, s60, 8448
    s_add_u32 s60, s60, 98304
    s_lshl_b32 s62, s61, 5
    s_add_u32 s62, s62, s60
    v_mul_u32_u24 v146, 528, v137
    v_lshl_add_u32 v146, v138, 3, v146
    v_add_u32 v237, s62, v146
    v_bfe_u32 v146, v0, 2, 4
    v_mul_u32_u24 v146, 528, v146
    v_and_b32 v147, 3, v0
    v_lshl_add_u32 v146, v147, 3, v146
    v_add_u32 v239, s62, v146
    v_lshlrev_b32 v146, 2, v138
    v_sub_u32 v146, v137, v146
    v_mov_b32 v147, 0x3f80
    v_mov_b32 v148, 0x3f800000
    v_cmp_eq_u32 vcc, 0, v146
    s_nop 1
    v_cndmask_b32 v240, 0, v147, vcc
    v_cmp_eq_u32 vcc, 1, v146
    s_nop 1
    v_cndmask_b32 v240, v240, v148, vcc
    v_cmp_eq_u32 vcc, 2, v146
    s_nop 1
    v_cndmask_b32 v241, 0, v147, vcc
    v_cmp_eq_u32 vcc, 3, v146
    s_nop 1
    v_cndmask_b32 v241, v241, v148, vcc
    s_mul_i32 s62, s61, 2112
    s_add_u32 s62, s62, s60
    s_add_u32 s62, s62, 16896
    v_bfe_u32 v146, v0, 5, 1
    v_mul_u32_u24 v146, 528, v146
    v_and_b32 v147, 31, v0
    v_lshl_add_u32 v146, v147, 4, v146
    v_add_u32 v238, s62, v146
    s_mov_b32 s62, 0
    buffer_load_dwordx4 v[104:107], v8, s[48:51], s62 offen offset:0
    buffer_load_dwordx4 v[108:111], v236, s[48:51], s62 offen offset:2048
    s_mov_b32 s62, 14336
    buffer_load_dwordx4 v[112:115], v8, s[48:51], s62 offen offset:0
    buffer_load_dwordx4 v[116:119], v236, s[48:51], s62 offen offset:2048
    s_mov_b32 s53, 0xffff0000
    s_mov_b32 s55, 0
    s_movk_i32 s56, 256
    s_movk_i32 s57, 512
    s_movk_i32 s58, 768
    s_mov_b32 s10, 0x80008000
    s_mov_b32 s17, 0x8000
    s_mul_i32 s11, s2, -14406
    s_mov_b32 s14, 135680
    s_mov_b32 s15, 132096
    v_mov_b32 v13, 0x3f803f80
    s_lshr_b32 s59, s52, 1
    s_lshl_b32 s60, s59, 2
    v_add_u32 v139, s60, v138
    v_xor_b32 v139, v139, v137
    v_lshlrev_b32 v1, 4, v139
    v_and_b32 v139, 1, v138
    v_lshl_or_b32 v139, v139, 1, s60
    v_xor_b32 v139, v139, v137
    v_lshlrev_b32 v2, 4, v139
    v_and_b32 v141, 3, v0
    v_lshlrev_b32 v141, 2, v141
    v_cmp_ne_u32 s[82:83], 0, v141
kb_pret:
    s_waitcnt vmcnt(13) lgkmcnt(0)
    v_and_b32 v208, 0xffff, v204
    s_nop 1
    v_mov_b32_dpp v208, v208 quad_perm:[0,0,0,0] row_mask:0xf bank_mask:0xf
    s_and_b32 s79, s71, s53
    s_lshl_b32 s78, s71, 16
    s_and_b32 s77, s70, s53
    s_lshl_b32 s76, s70, 16
    s_and_b32 s75, s69, s53
    s_lshl_b32 s74, s69, 16
    s_and_b32 s73, s68, s53
    s_lshl_b32 s72, s68, 16
    s_and_b32 s71, s67, s53
    s_lshl_b32 s70, s67, 16
    s_and_b32 s69, s66, s53
    s_lshl_b32 s68, s66, 16
    s_and_b32 s67, s65, s53
    s_lshl_b32 s66, s65, 16
    s_and_b32 s65, s64, s53
    s_lshl_b32 s64, s64, 16
    v_sub_u32 v209, v208, v141
    v_cmp_lt_i32 vcc, 0, v209
    s_and_b64 s[80:81], vcc, s[82:83]
    v_cmp_lt_i32 s[82:83], 16, v209
kb_propose:
    v_mov_b32 v145, 1
    v_mov_b32 v210, 147
    v_and_b32 v136, 63, v0
    v_lshlrev_b32 v211, 4, v136
    v_lshlrev_b32 v212, 3, v136
    v_lshrrev_b32 v172, 16, v204
    v_mad_u32_u24 v172, v172, v210, s11
    v_lshrrev_b32 v172, 11, v172
    v_lshl_add_u32 v176, v172, 2, s14
    v_lshrrev_b32 v173, 16, v205
    v_mad_u32_u24 v173, v173, v210, s11
    v_lshrrev_b32 v173, 11, v173
    v_lshl_add_u32 v177, v173, 2, s14
    s_mov_b64 exec, s[80:81]
    ds_add_rtn_u32 v180, v176, v145
    s_mov_b64 exec, s[82:83]
    ds_add_rtn_u32 v181, v177, v145
    s_mov_b64 exec, -1
    v_lshl_add_u32 v172, v172, 9, s15
    v_lshl_add_u32 v173, v173, 9, s15
    s_waitcnt lgkmcnt(0)
    v_min_u32 v180, 0x7f, v180
    v_lshl_add_u32 v172, v180, 2, v172
    v_min_u32 v181, 0x7f, v181
    v_lshl_add_u32 v173, v181, 2, v173
    s_mov_b64 exec, s[80:81]
    ds_write_b32 v172, v204
    s_mov_b64 exec, s[82:83]
    ds_write_b32 v173, v205
    s_mov_b64 exec, -1
    v_cmp_lt_u32 vcc, 32, v208
    s_cbranch_vccz kb_prop_done
    v_cmp_lt_i32 s[80:81], 32, v209
    v_cmp_lt_i32 s[82:83], 48, v209
    v_lshrrev_b32 v172, 16, v206
    v_mad_u32_u24 v172, v172, v210, s11
    v_lshrrev_b32 v172, 11, v172
    v_lshl_add_u32 v176, v172, 2, s14
    v_lshrrev_b32 v173, 16, v207
    v_mad_u32_u24 v173, v173, v210, s11
    v_lshrrev_b32 v173, 11, v173
    v_lshl_add_u32 v177, v173, 2, s14
    s_mov_b64 exec, s[80:81]
    ds_add_rtn_u32 v180, v176, v145
    s_mov_b64 exec, s[82:83]
    ds_add_rtn_u32 v181, v177, v145
    s_mov_b64 exec, -1
    v_lshl_add_u32 v172, v172, 9, s15
    v_lshl_add_u32 v173, v173, 9, s15
    s_waitcnt lgkmcnt(0)
    v_min_u32 v180, 0x7f, v180
    v_lshl_add_u32 v172, v180, 2, v172
    v_min_u32 v181, 0x7f, v181
    v_lshl_add_u32 v173, v181, 2, v173
    s_mov_b64 exec, s[80:81]
    ds_write_b32 v172, v206
    s_mov_b64 exec, s[82:83]
    ds_write_b32 v173, v207
    s_mov_b64 exec, -1
    v_cmp_lt_u32 vcc, 64, v208
    v_mov_b32 v172, 135708
    s_mov_b64 exec, vcc
    ds_add_u32 v172, v145
    s_mov_b64 exec, -1
kb_prop_done:
    v_mov_b32 v172, 135680
    s_waitcnt lgkmcnt(0)
    s_barrier
    ds_read_b128 v[176:179], v172
    ds_read_b128 v[180:183], v172 offset:16
    v_and_b32 v137, 15, v0
    v_bfe_u32 v138, v0, 4, 2
    v_lshrrev_b32 v140, 2, v136
    v_and_b32 v141, 3, v136
    s_lshl_b32 s59, s52, 2
    v_add_u32 v142, s59, v141
    v_lshl_add_u32 v139, v140, 5, v142
    v_lshl_add_u32 v143, v139, 2, s15
    s_waitcnt lgkmcnt(0)
    v_readfirstlane_b32 s80, v176
    v_readfirstlane_b32 s81, v177
    v_readfirstlane_b32 s82, v178
    v_readfirstlane_b32 s83, v179
    v_readfirstlane_b32 s84, v180
    v_readfirstlane_b32 s85, v181
    v_readfirstlane_b32 s86, v182
    v_readfirstlane_b32 s87, v183
    s_max_u32 s97, s80, s81
    s_max_u32 s98, s82, s83
    s_max_u32 s99, s84, s85
    s_max_u32 s97, s97, s86
    s_max_u32 s98, s98, s99
    s_max_u32 s97, s97, s98
    s_mov_b32 s92, 0
    s_add_u32 s92, s92, s80
    s_lshl_b32 s98, s80, 2
    s_sub_u32 s98, 512, s98
    v_cmpx_le_u32 vcc, s92, v139
    v_add_u32 v143, s98, v143
    s_mov_b32 s80, s92
    s_add_u32 s92, s92, s81
    s_lshl_b32 s98, s81, 2
    s_sub_u32 s98, 512, s98
    v_cmpx_le_u32 vcc, s92, v139
    v_add_u32 v143, s98, v143
    s_mov_b32 s81, s92
    s_add_u32 s92, s92, s82
    s_lshl_b32 s98, s82, 2
    s_sub_u32 s98, 512, s98
    v_cmpx_le_u32 vcc, s92, v139
    v_add_u32 v143, s98, v143
    s_mov_b32 s82, s92
    s_add_u32 s92, s92, s83
    s_lshl_b32 s98, s83, 2
    s_sub_u32 s98, 512, s98
    v_cmpx_le_u32 vcc, s92, v139
    v_add_u32 v143, s98, v143
    s_mov_b32 s83, s92
    s_add_u32 s92, s92, s84
    s_lshl_b32 s98, s84, 2
    s_sub_u32 s98, 512, s98
    v_cmpx_le_u32 vcc, s92, v139
    v_add_u32 v143, s98, v143
    s_mov_b32 s84, s92
    s_add_u32 s92, s92, s85
    s_lshl_b32 s98, s85, 2
    s_sub_u32 s98, 512, s98
    v_cmpx_le_u32 vcc, s92, v139
    v_add_u32 v143, s98, v143
    s_mov_b32 s85, s92
    s_add_u32 s92, s92, s86
    s_mov_b32 s86, s92
    s_mov_b64 exec, -1
    ds_read_b32 v144, v143
    s_cmp_gt_u32 s97, 128
    s_cselect_b32 s87, 1, s87
    s_cmp_gt_u32 s92, 416
    s_cselect_b32 s87, 1, s87
    s_cmp_lg_u32 s87, 0
    s_cbranch_scc1 kb_go_slow
    s_cmp_eq_u32 s92, 0
    s_cbranch_scc1 kb_empty
    s_lshl_b32 s59, s81, 9
    s_or_b32 s90, s80, s59
    s_lshl_b32 s59, s82, 18
    s_or_b32 s90, s90, s59
    s_lshl_b32 s59, s83, 27
    s_or_b32 s90, s90, s59
    s_lshr_b32 s91, s83, 5
    s_lshl_b32 s59, s84, 4
    s_or_b32 s91, s91, s59
    s_lshl_b32 s59, s85, 13
    s_or_b32 s91, s91, s59
    s_lshl_b32 s59, s86, 22
    s_or_b32 s91, s91, s59
    v_cmp_gt_u32 vcc, s92, v139
    v_mov_b32 v145, 1048576
    v_mov_b32 v146, 0x3fff
    v_lshlrev_b32 v6, 2, v138
    s_waitcnt lgkmcnt(0)
    v_and_b32 v147, 0xffff, v144
    v_lshrrev_b32 v148, 16, v144
    v_cndmask_b32 v9, v145, v147, vcc
    v_cndmask_b32 v149, v145, v148, vcc
    ds_bpermute_b32 v216, v6, v9
    ds_bpermute_b32 v217, v6, v9 offset:16
    ds_bpermute_b32 v10, v6, v9 offset:32
    v_add_u32 v6, 48, v6
    v_mul_u32_u24 v150, 6, v9
    v_and_b32 v150, -4, v150
    v_mul_u32_u24 v151, 6, v149
    v_and_b32 v151, -4, v151
    buffer_load_dwordx2 v[152:153], v150, s[40:43], 0 offen
    buffer_load_dwordx2 v[154:155], v151, s[40:43], 0 offen
    v_subrev_u32 v148, s54, v148
    v_cndmask_b32 v146, v146, v148, vcc
    v_lshlrev_b32 v146, 1, v146
    s_lshl_b32 s100, s52, 12
    s_waitcnt lgkmcnt(1)
    s_mul_i32 s61, s52, 1536
    s_add_u32 s61, s61, 131072
    v_lshl_add_u32 v11, v216, 8, v1
    v_lshl_add_u32 v12, v216, 10, v2
    s_mov_b32 m0, s100
    s_nop 0
    buffer_load_dwordx4 v11, s[36:39], 0 offen sc0 lds
    s_add_u32 m0, s100, 1024
    s_nop 0
    buffer_load_dwordx4 v12, s[28:31], s56 offen sc0 lds
    s_add_u32 m0, s100, 2048
    s_nop 0
    buffer_load_dwordx4 v12, s[28:31], s57 offen sc0 lds
    s_add_u32 m0, s100, 3072
    s_nop 0
    buffer_load_dwordx4 v12, s[28:31], s58 offen sc0 lds
    s_add_u32 s100, s100, 0x8000
    s_cmp_ge_u32 s100, 0x18000
    s_cselect_b32 s18, 0x18000, 0
    s_sub_u32 s100, s100, s18
    s_bitcmp0_b32 s2, 3
    s_cbranch_scc1 kb_wb1_1
    s_add_u32 s60, s16, 0
    buffer_load_dwordx4 v[20:23], v211, s[44:47], s60 offen offset:0
    buffer_load_dwordx4 v[24:27], v211, s[44:47], s60 offen offset:1024
    buffer_load_dwordx4 v[28:31], v211, s[44:47], s60 offen offset:2048
    buffer_load_dwordx4 v[32:35], v211, s[44:47], s60 offen offset:3072
    s_add_u32 s60, s60, 4096
    buffer_load_dwordx4 v[36:39], v211, s[44:47], s60 offen offset:0
    buffer_load_dwordx4 v[40:43], v211, s[44:47], s60 offen offset:1024
    s_branch kb_wb1_e
kb_wb1_1:
    s_add_u32 s60, s16, 6144
    buffer_load_dwordx4 v[44:47], v211, s[44:47], s60 offen offset:0
    buffer_load_dwordx4 v[48:51], v211, s[44:47], s60 offen offset:1024
    buffer_load_dwordx4 v[52:55], v211, s[44:47], s60 offen offset:2048
    buffer_load_dwordx4 v[56:59], v211, s[44:47], s60 offen offset:3072
    s_add_u32 s60, s60, 4096
    buffer_load_dwordx4 v[60:63], v211, s[44:47], s60 offen offset:0
    buffer_load_dwordx4 v[64:67], v211, s[44:47], s60 offen offset:1024
kb_wb1_e:
    s_mov_b32 s62, 28672
    buffer_load_dwordx4 v[80:83], v8, s[48:51], s62 offen offset:0
    buffer_load_dwordx4 v[84:87], v236, s[48:51], s62 offen offset:2048
    v_lshrrev_b32 v172, 2, v137
    v_lshlrev_b32 v172, 13, v172
    v_and_b32 v173, 3, v137
    v_lshl_or_b32 v172, v173, 8, v172
    v_xor_b32 v173, v138, v137
    v_xor_b32 v174, 0, v173
    v_lshl_or_b32 v16, v174, 4, v172
    v_xor_b32 v174, 4, v173
    v_lshl_or_b32 v17, v174, 4, v172
    v_xor_b32 v174, 8, v173
    v_lshl_or_b32 v18, v174, 4, v172
    v_xor_b32 v174, 12, v173
    v_lshl_or_b32 v19, v174, 4, v172
    v_bfe_u32 v172, v136, 3, 1
    v_lshl_or_b32 v173, v138, 1, v172
    v_xor_b32 v173, s52, v173
    v_lshlrev_b32 v173, 5, v173
    v_lshl_or_b32 v173, v172, 8, v173
    v_lshl_or_b32 v173, v138, 13, v173
    v_lshl_or_b32 v173, v141, 3, v173
    v_and_b32 v174, 4, v136
    v_xor_b32 v174, 4, v174
    v_lshl_or_b32 v3, v174, 18, v173
    v_lshlrev_b32 v4, 3, v136
    v_add_u32 v4, 135744, v4
    v_lshlrev_b32 v5, 5, v138
    v_add_u32 v5, 152128, v5
    v_lshlrev_b32 v7, 1, v137
    v_lshl_or_b32 v7, v7, 16, v7
    s_and_b32 s59, s52, 1
    s_lshl_b32 s61, s59, 3
    s_lshl_b32 s59, s59, 9
    s_lshr_b32 s60, s52, 1
    s_lshl_b32 s60, s60, 5
    s_add_u32 s61, s61, s60
    s_add_u32 s61, s61, 152512
    s_add_u32 s59, s59, s60
    s_add_u32 s59, s59, 135744
    v_lshlrev_b32 v156, 10, v140
    v_lshl_add_u32 v156, v141, 3, v156
    v_add_u32 v156, s59, v156
    v_lshlrev_b32 v157, 9, v140
    v_lshl_add_u32 v158, v141, 1, v157
    v_add_u32 v158, s61, v158
    v_lshl_add_u32 v157, v142, 2, v157
    v_add_u32 v157, 152128, v157
    ds_write_b16 v158, v146
    v_lshlrev_b32 v150, 4, v9
    v_lshlrev_b32 v151, 4, v149
    s_waitcnt vmcnt(12)
    v_alignbit_b32 v180, v153, v152, v150
    v_lshrrev_b32 v181, v150, v153
    v_alignbit_b32 v182, v155, v154, v151
    v_lshrrev_b32 v183, v151, v155
    v_lshlrev_b32 v172, 16, v180
    v_and_b32 v173, s53, v180
    v_lshlrev_b32 v174, 16, v181
    v_lshlrev_b32 v175, 16, v182
    v_lshl_add_u32 v11, v217, 8, v1
    v_lshl_add_u32 v12, v217, 10, v2
    s_mov_b32 m0, s100
    s_nop 0
    buffer_load_dwordx4 v11, s[36:39], 0 offen sc0 lds
    v_and_b32 v176, s53, v182
    v_lshlrev_b32 v177, 16, v183
    v_sub_f32 v172, v172, v175
    v_sub_f32 v173, v173, v176
    v_sub_f32 v174, v174, v177
    v_cvt_pk_bf16_f32 v172, 0, v172
    v_cvt_pk_bf16_f32 v173, 0, v173
    v_cvt_pk_bf16_f32 v174, 0, v174
    s_add_u32 m0, s100, 1024
    s_nop 0
    buffer_load_dwordx4 v12, s[28:31], s56 offen sc0 lds
    v_mul_f32 v175, v172, v172
    v_mul_f32 v176, v173, v173
    v_mul_f32 v177, v174, v174
    v_cvt_pk_bf16_f32 v175, 0, v175
    v_cvt_pk_bf16_f32 v176, 0, v176
    v_cvt_pk_bf16_f32 v177, 0, v177
    v_add_f32 v175, v175, v176
    v_add_f32 v175, v175, v177
    s_add_u32 m0, s100, 2048
    s_nop 0
    buffer_load_dwordx4 v12, s[28:31], s57 offen sc0 lds
    v_cvt_pk_bf16_f32 v175, 0, v175
    v_add_f32 v175, 0x322bcc77, v175
    v_cvt_pk_bf16_f32 v175, 0, v175
    v_sqrt_f32 v175, v175
    s_nop 0
    v_cvt_pk_bf16_f32 v175, 0, v175
    v_rcp_f32 v176, v175
    v_mul_f32 v184, s64, v175
    v_mul_f32 v185, s65, v175
    s_add_u32 m0, s100, 3072
    s_nop 0
    buffer_load_dwordx4 v12, s[28:31], s58 offen sc0 lds
    s_add_u32 s100, s100, 0x8000
    s_cmp_ge_u32 s100, 0x18000
    s_cselect_b32 s18, 0x18000, 0
    s_sub_u32 s100, s100, s18
    v_mul_f32 v186, s66, v175
    v_mul_f32 v187, s67, v175
    v_mul_f32 v188, s68, v175
    v_mul_f32 v189, s69, v175
    v_mul_f32 v190, s70, v175
    v_mul_f32 v191, s71, v175
    v_mul_f32 v192, s72, v175
    v_mul_f32 v193, s73, v175
    v_mul_f32 v194, s74, v175
    v_mul_f32 v195, s75, v175
    v_mul_f32 v196, s76, v175
    v_mul_f32 v197, s77, v175
    v_mul_f32 v198, s78, v175
    v_mul_f32 v199, s79, v175
    v_mul_f32 v177, 0x40490fdb, v175
    v_mul_f32 v172, v172, v176
    v_cvt_pk_bf16_f32 v177, 0, v177
    v_mul_f32 v173, v173, v176
    v_mul_f32 v177, 0x3e4ccccd, v177
    v_mul_f32 v174, v174, v176
    v_cvt_pk_bf16_f32 v177, 0, v177
    v_cvt_pk_bf16_f32 v172, 0, v172
    v_mul_f32 v177, 0.15915494, v177
    v_cvt_pk_bf16_f32 v173, 0, v173
    v_cos_f32 v177, v177
    v_cvt_pk_bf16_f32 v174, 0, v174
    v_cvt_pk_bf16_f32 v177, 0, v177
    ds_write_b32 v157, v172
    v_add_f32 v177, 1.0, v177
    ds_write_b32 v157, v173 offset:128
    v_cvt_pk_bf16_f32 v177, 0, v177
    ds_write_b32 v157, v174 offset:256
    v_mul_f32 v177, 0.5, v177
    v_cmp_gt_f32 vcc, 0x40a00000, v175
    s_nop 1
    v_cndmask_b32 v177, 0, v177, vcc
    v_mul_f32 v176, v176, v177
    v_cvt_pk_bf16_f32 v184, 0, v184
    v_cvt_pk_bf16_f32 v185, 0, v185
    v_cvt_pk_bf16_f32 v186, 0, v186
    v_cvt_pk_bf16_f32 v187, 0, v187
    v_cvt_pk_bf16_f32 v188, 0, v188
    v_cvt_pk_bf16_f32 v189, 0, v189
    v_cvt_pk_bf16_f32 v190, 0, v190
    v_cvt_pk_bf16_f32 v191, 0, v191
    v_cvt_pk_bf16_f32 v192, 0, v192
    v_cvt_pk_bf16_f32 v193, 0, v193
    v_cvt_pk_bf16_f32 v194, 0, v194
    v_cvt_pk_bf16_f32 v195, 0, v195
    v_cvt_pk_bf16_f32 v196, 0, v196
    v_cvt_pk_bf16_f32 v197, 0, v197
    v_cvt_pk_bf16_f32 v198, 0, v198
    v_cvt_pk_bf16_f32 v199, 0, v199
    v_mul_f32 v184, 0.15915494, v184
    v_mul_f32 v185, 0.15915494, v185
    v_mul_f32 v186, 0.15915494, v186
    v_mul_f32 v187, 0.15915494, v187
    v_mul_f32 v188, 0.15915494, v188
    v_mul_f32 v189, 0.15915494, v189
    v_mul_f32 v190, 0.15915494, v190
    v_mul_f32 v191, 0.15915494, v191
    v_mul_f32 v192, 0.15915494, v192
    v_mul_f32 v193, 0.15915494, v193
    v_mul_f32 v194, 0.15915494, v194
    v_mul_f32 v195, 0.15915494, v195
    v_mul_f32 v196, 0.15915494, v196
    v_mul_f32 v197, 0.15915494, v197
    v_mul_f32 v198, 0.15915494, v198
    v_mul_f32 v199, 0.15915494, v199
    v_sin_f32 v184, v184
    v_sin_f32 v185, v185
    v_sin_f32 v186, v186
    v_sin_f32 v187, v187
    v_sin_f32 v188, v188
    v_sin_f32 v189, v189
    v_sin_f32 v190, v190
    v_sin_f32 v191, v191
    v_sin_f32 v192, v192
    v_sin_f32 v193, v193
    v_sin_f32 v194, v194
    v_sin_f32 v195, v195
    v_sin_f32 v196, v196
    v_sin_f32 v197, v197
    v_sin_f32 v198, v198
    v_sin_f32 v199, v199
    v_mul_f32 v184, v184, v176
    v_mul_f32 v185, v185, v176
    v_mul_f32 v186, v186, v176
    v_mul_f32 v187, v187, v176
    v_mul_f32 v188, v188, v176
    v_mul_f32 v189, v189, v176
    v_mul_f32 v190, v190, v176
    v_mul_f32 v191, v191, v176
    v_mul_f32 v192, v192, v176
    v_mul_f32 v193, v193, v176
    v_mul_f32 v194, v194, v176
    v_mul_f32 v195, v195, v176
    v_mul_f32 v196, v196, v176
    v_mul_f32 v197, v197, v176
    v_mul_f32 v198, v198, v176
    v_mul_f32 v199, v199, v176
    v_cvt_pk_bf16_f32 v160, v184, v185
    v_cvt_pk_bf16_f32 v161, v186, v187
    v_cvt_pk_bf16_f32 v162, v188, v189
    v_cvt_pk_bf16_f32 v163, v190, v191
    v_cvt_pk_bf16_f32 v164, v192, v193
    v_cvt_pk_bf16_f32 v165, v194, v195
    v_cvt_pk_bf16_f32 v166, v196, v197
    v_cvt_pk_bf16_f32 v167, v198, v199
    ds_write_b64 v156, v[160:161] offset:0
    ds_write_b64 v156, v[162:163] offset:128
    ds_write_b64 v156, v[164:165] offset:256
    ds_write_b64 v156, v[166:167] offset:384
    s_mov_b32 s96, 0
    s_and_b32 s94, s90, 0x1ff
    s_mov_b32 s93, 32
    s_mov_b32 s97, 28672
    s_mov_b32 s98, 0x40000000
    s_mov_b32 s101, 0x8000
    s_mov_b32 s19, 0
    s_mov_b32 s13, 16896
    s_mov_b32 s8, 0
    s_mov_b32 s9, 3
    s_cmp_lg_u32 s55, 0
    s_cbranch_scc1 kb_slow_own
    v_subrev_u32 v136, 16896, v238
    ds_write_b128 v136, v[104:107] offset:0
    ds_write_b128 v136, v[108:111] offset:1056
    ds_write_b128 v136, v[112:115] offset:16896
    ds_write_b128 v136, v[116:119] offset:17952
kb_slow_ownr:
    v_mov_b32 v120, 0
    v_mov_b32 v121, 0
    v_mov_b32 v122, 0
    v_mov_b32 v123, 0
    v_mov_b32 v124, 0
    v_mov_b32 v125, 0
    v_mov_b32 v126, 0
    v_mov_b32 v127, 0
    v_mov_b32 v128, 0
    v_mov_b32 v129, 0
    v_mov_b32 v130, 0
    v_mov_b32 v131, 0
    v_mov_b32 v132, 0
    v_mov_b32 v133, 0
    v_mov_b32 v134, 0
    v_mov_b32 v135, 0
    s_cmp_ge_u32 s52, 4
    s_waitcnt vmcnt(6) lgkmcnt(0)
    s_cbranch_scc1 kb_B_entry
kb_loopA:
    s_setprio 2
    s_barrier
    ds_read_b128 v[172:175], v16
    ds_read_b128 v[176:179], v17
    ds_read_b128 v[180:183], v18
    ds_read_b128 v[184:187], v19
    ds_read_b64 v[74:75], v4
    s_cmp_lt_u32 s9, 7
    s_cbranch_scc1 kb_ownA
kb_ownrA:
    v_lshl_add_u32 v11, v10, 8, v1
    v_lshl_add_u32 v12, v10, 10, v2
    s_mov_b32 m0, s100
    ds_bpermute_b32 v10, v6, v9
    buffer_load_dwordx4 v11, s[36:39], 0 offen sc0 lds
    v_add_u32 v6, 16, v6
    s_waitcnt lgkmcnt(5)
    v_mfma_f32_16x16x32_bf16 v[136:139], v[172:175], v[20:23], 0
    ds_read_b128 v[188:191], v16 offset:4096
    v_mfma_f32_16x16x32_bf16 v[140:143], v[172:175], v[36:39], 0
    ds_read_b128 v[192:195], v17 offset:4096
    v_mfma_f32_16x16x32_bf16 v[144:147], v[172:175], v[52:55], 0
    ds_read_b128 v[196:199], v18 offset:4096
    s_waitcnt lgkmcnt(7)
    v_mfma_f32_16x16x32_bf16 v[136:139], v[176:179], v[24:27], v[136:139]
    ds_read_b128 v[200:203], v19 offset:4096
    v_mfma_f32_16x16x32_bf16 v[140:143], v[176:179], v[40:43], v[140:143]
    ds_read_b64 v[76:77], v4 offset:512
    v_add_u32 v16, s101, v16
    v_mfma_f32_16x16x32_bf16 v[144:147], v[176:179], v[56:59], v[144:147]
    ds_read_b64_tr_b16 v[204:205], v3 offset:1024
    v_add_u32 v17, s101, v17
    s_waitcnt lgkmcnt(9)
    s_add_u32 m0, s100, 1024
    v_mfma_f32_16x16x32_bf16 v[136:139], v[180:183], v[28:31], v[136:139]
    buffer_load_dwordx4 v12, s[28:31], s56 offen sc0 lds
    ds_read_b64_tr_b16 v[206:207], v3 offset:1536
    v_add_u32 v18, s101, v18
    v_mfma_f32_16x16x32_bf16 v[140:143], v[180:183], v[44:47], v[140:143]
    ds_read_b64_tr_b16 v[208:209], v3 offset:2048
    v_add_u32 v19, s101, v19
    v_mfma_f32_16x16x32_bf16 v[144:147], v[180:183], v[60:63], v[144:147]
    ds_read_b64_tr_b16 v[210:211], v3 offset:2560
    v_add_u32 v4, 1024, v4
    s_waitcnt lgkmcnt(11)
    v_mfma_f32_16x16x32_bf16 v[136:139], v[184:187], v[32:35], v[136:139]
    ds_read_b64_tr_b16 v[212:213], v3 offset:3072
    v_mfma_f32_16x16x32_bf16 v[140:143], v[184:187], v[48:51], v[140:143]
    ds_read_b64_tr_b16 v[214:215], v3 offset:3584
    v_mfma_f32_16x16x32_bf16 v[144:147], v[184:187], v[64:67], v[144:147]
    s_waitcnt lgkmcnt(12)
    v_mfma_f32_16x16x16_bf16 v[160:163], v[74:75], v[68:69], 0
    ds_read_b128 v[172:175], v5 offset:0
    s_add_u32 m0, s100, 2048
    v_mfma_f32_16x16x16_bf16 v[164:167], v[74:75], v[70:71], 0
    buffer_load_dwordx4 v12, s[28:31], s57 offen sc0 lds
    ds_read_b128 v[176:179], v5 offset:128
    v_mfma_f32_16x16x16_bf16 v[168:171], v[74:75], v[72:73], 0
    ds_read_b128 v[180:183], v5 offset:256
    s_waitcnt lgkmcnt(9)
    v_mfma_f32_16x16x32_bf16 v[148:151], v[188:191], v[20:23], 0
    ds_read_b64_tr_b16 v[216:217], v3 offset:5120
    v_mfma_f32_16x16x32_bf16 v[152:155], v[188:191], v[36:39], 0
    ds_read_b64_tr_b16 v[218:219], v3 offset:5632
    v_mfma_f32_16x16x32_bf16 v[156:159], v[188:191], v[52:55], 0
    ds_read_b64_tr_b16 v[220:221], v3 offset:6144
    v_mul_f32 v144, v144, v168
    v_mul_f32 v145, v145, v169
    v_mfma_f32_16x16x32_bf16 v[148:151], v[192:195], v[24:27], v[148:151]
    ds_read_b64_tr_b16 v[222:223], v3 offset:6656
    v_mul_f32 v146, v146, v170
    v_mul_f32 v147, v147, v171
    v_mfma_f32_16x16x32_bf16 v[152:155], v[192:195], v[40:43], v[152:155]
    ds_read_b64_tr_b16 v[224:225], v3 offset:7168
    v_mul_f32 v136, v136, v160
    v_mul_f32 v137, v137, v161
    s_add_u32 m0, s100, 3072
    v_mfma_f32_16x16x32_bf16 v[156:159], v[192:195], v[56:59], v[156:159]
    buffer_load_dwordx4 v12, s[28:31], s58 offen sc0 lds
    s_add_u32 s100, s100, 0x8000
    s_cmp_ge_u32 s100, 0x18000
    s_cselect_b32 s18, 0x18000, 0
    s_sub_u32 s100, s100, s18
    ds_read_b64_tr_b16 v[226:227], v3 offset:7680
    v_mul_f32 v138, v138, v162
    v_mul_f32 v139, v139, v163
    v_mfma_f32_16x16x32_bf16 v[148:151], v[196:199], v[28:31], v[148:151]
    s_waitcnt lgkmcnt(8)
    ds_read_b128 v[184:187], v5 offset:384
    v_mul_f32 v140, v140, v164
    v_mul_f32 v141, v141, v165
    v_add_u32 v3, s101, v3
    v_mfma_f32_16x16x32_bf16 v[152:155], v[196:199], v[44:47], v[152:155]
    v_mul_f32 v142, v142, v166
    v_mul_f32 v143, v143, v167
    s_add_u32 s19, s19, s101
    v_mfma_f32_16x16x32_bf16 v[156:159], v[196:199], v[60:63], v[156:159]
    v_cvt_pk_bf16_f32 v74, v136, v137
    v_cvt_pk_bf16_f32 v75, v138, v139
    s_cmp_eq_u32 s19, 0x10000
    s_cselect_b32 s101, 0xffff0000, s17
    v_mfma_f32_16x16x32_bf16 v[148:151], v[200:203], v[32:35], v[148:151]
    ds_read_b128 v[188:191], v5 offset:16
    s_waitcnt lgkmcnt(8)
    v_mul_f32 v172, v172, v144
    v_mul_f32 v173, v173, v145
    v_mfma_f32_16x16x32_bf16 v[152:155], v[200:203], v[48:51], v[152:155]
    ds_read_b128 v[192:195], v5 offset:144
    v_mul_f32 v174, v174, v146
    v_mul_f32 v175, v175, v147
    v_mfma_f32_16x16x32_bf16 v[156:159], v[200:203], v[64:67], v[156:159]
    ds_read_b128 v[196:199], v5 offset:272
    v_mul_f32 v176, v176, v144
    v_mul_f32 v177, v177, v145
    v_mfma_f32_16x16x16_bf16 v[160:163], v[76:77], v[68:69], 0
    v_mul_f32 v178, v178, v146
    v_mul_f32 v179, v179, v147
    v_add_u32 v5, 512, v5
    v_mfma_f32_16x16x16_bf16 v[164:167], v[76:77], v[70:71], 0
    v_mul_f32 v180, v180, v144
    v_mul_f32 v181, v181, v145
    v_mfma_f32_16x16x16_bf16 v[168:171], v[76:77], v[72:73], 0
    v_mul_f32 v182, v182, v146
    v_mul_f32 v183, v183, v147
    s_setprio 0
    ds_read_b128 v[228:231], v238
    ds_read_b128 v[232:235], v238 offset:1056
    s_waitcnt lgkmcnt(5)
    v_xor_b32 v200, v184, v7
    v_xor_b32 v201, v185, v7
    v_xor_b32 v202, v186, v7
    v_xor_b32 v203, v187, v7
    v_fmac_f32 v172, v204, v140
    v_fmac_f32 v173, v205, v141
    v_fmac_f32 v174, v206, v142
    v_fmac_f32 v175, v207, v143
    v_fmac_f32 v176, v208, v140
    v_fmac_f32 v177, v209, v141
    v_fmac_f32 v178, v210, v142
    v_fmac_f32 v179, v211, v143
    v_fmac_f32 v180, v212, v140
    v_fmac_f32 v181, v213, v141
    v_fmac_f32 v182, v214, v142
    v_fmac_f32 v183, v215, v143
    v_pk_mad_i16 v200, v200, s10, v13 clamp
    v_pk_mad_i16 v201, v201, s10, v13 clamp
    v_pk_mad_i16 v202, v202, s10, v13 clamp
    v_pk_mad_i16 v203, v203, s10, v13 clamp
    v_mul_f32 v148, v148, v160
    v_mul_f32 v149, v149, v161
    v_mul_f32 v150, v150, v162
    v_mul_f32 v151, v151, v163
    v_mul_f32 v152, v152, v164
    v_mul_f32 v153, v153, v165
    v_mul_f32 v154, v154, v166
    v_mul_f32 v155, v155, v167
    v_mul_f32 v156, v156, v168
    v_mul_f32 v157, v157, v169
    v_mul_f32 v158, v158, v170
    v_mul_f32 v159, v159, v171
    v_cvt_pk_bf16_f32 v76, v148, v149
    v_cvt_pk_bf16_f32 v77, v150, v151
    s_waitcnt lgkmcnt(2)
    ds_read_b64_tr_b16 v[204:205], v239 offset:0
    ds_read_b64_tr_b16 v[206:207], v239 offset:128
    ds_read_b64_tr_b16 v[208:209], v239 offset:256
    ds_read_b64_tr_b16 v[210:211], v239 offset:384
    v_mul_f32 v188, v188, v156
    v_mul_f32 v189, v189, v157
    v_mul_f32 v190, v190, v158
    v_mul_f32 v191, v191, v159
    v_fmac_f32 v188, v216, v152
    v_fmac_f32 v189, v217, v153
    v_fmac_f32 v190, v218, v154
    v_fmac_f32 v191, v219, v155
    v_cvt_pk_bf16_f32 v160, v172, v173
    v_cvt_pk_bf16_f32 v161, v174, v175
    v_cvt_pk_bf16_f32 v162, v188, v189
    v_cvt_pk_bf16_f32 v163, v190, v191
    v_mul_f32 v192, v192, v156
    v_mul_f32 v193, v193, v157
    v_mul_f32 v194, v194, v158
    v_mul_f32 v195, v195, v159
    v_fmac_f32 v192, v220, v152
    v_fmac_f32 v193, v221, v153
    v_fmac_f32 v194, v222, v154
    v_fmac_f32 v195, v223, v155
    v_cvt_pk_bf16_f32 v164, v176, v177
    v_cvt_pk_bf16_f32 v165, v178, v179
    v_cvt_pk_bf16_f32 v166, v192, v193
    v_cvt_pk_bf16_f32 v167, v194, v195
    v_mul_f32 v196, v196, v156
    v_mul_f32 v197, v197, v157
    v_mul_f32 v198, v198, v158
    v_mul_f32 v199, v199, v159
    v_fmac_f32 v196, v224, v152
    v_fmac_f32 v197, v225, v153
    v_fmac_f32 v198, v226, v154
    v_fmac_f32 v199, v227, v155
    v_cvt_pk_bf16_f32 v168, v180, v181
    v_cvt_pk_bf16_f32 v169, v182, v183
    v_cvt_pk_bf16_f32 v170, v196, v197
    v_cvt_pk_bf16_f32 v171, v198, v199
    s_setprio 3
    v_mfma_f32_16x16x32_bf16 v[120:123], v[74:77], v[200:203], v[120:123]
    v_mfma_f32_16x16x32_bf16 v[124:127], v[160:163], v[200:203], v[124:127]
    v_mfma_f32_16x16x32_bf16 v[128:131], v[164:167], v[200:203], v[128:131]
    v_mfma_f32_16x16x32_bf16 v[132:135], v[168:171], v[200:203], v[132:135]
    s_setprio 0
    s_waitcnt lgkmcnt(0)
    buffer_store_dwordx4 v[228:231], v8, s[32:35], s98 offen offset:0 sc0 sc1
    buffer_store_dwordx4 v[232:235], v236, s[32:35], s98 offen offset:2048 sc0 sc1
    s_bitcmp1_b32 s98, 30
    s_cbranch_scc1 kb_segendA
    s_sub_u32 s60, s96, 8
    s_min_u32 s60, s60, 32
    s_lshl_b32 s59, s60, 2
    s_add_u32 s59, s59, 32
    s_cmp_gt_u32 s59, s8
    s_cbranch_scc1 kb_fbrA
kb_fbrrA:
    s_set_gpr_idx_on s60, 0x1
    s_mov_b32 s98, 0x40000000
    s_waitcnt vmcnt(12)
    v_mov_b32 v212, v80
    v_mov_b32 v213, v81
    v_mov_b32 v214, v82
    v_mov_b32 v215, v83
    v_mov_b32 v216, v84
    v_mov_b32 v217, v85
    v_mov_b32 v218, v86
    v_mov_b32 v219, v87
    s_set_gpr_idx_off
    ds_write_b128 v238, v[212:215] offset:0
    ds_write_b128 v238, v[216:219] offset:1056
kb_segendA:
    s_cmp_gt_u32 s94, s93
    s_cbranch_scc1 kb_nextA
kb_flushA:
    s_bitcmp0_b32 s98, 30
    s_cbranch_scc1 kb_extraA
kb_extrarA:
    s_setprio 3
    v_mfma_f32_16x16x16_bf16 v[120:123], v[204:205], v[240:241], v[120:123]
    v_mfma_f32_16x16x16_bf16 v[124:127], v[206:207], v[240:241], v[124:127]
    v_mfma_f32_16x16x16_bf16 v[128:131], v[208:209], v[240:241], v[128:131]
    v_mfma_f32_16x16x16_bf16 v[132:135], v[210:211], v[240:241], v[132:135]
    v_add_u32 v7, 0x001c001c, v7
    s_mul_i32 s98, s96, 1792
    s_add_u32 s96, s96, 8
    s_lshr_b64 s[90:91], s[90:91], 9
    s_mov_b32 s95, s94
    s_and_b32 s94, s90, 0x1ff
    v_xor_b32 v200, v184, v7
    v_xor_b32 v201, v185, v7
    v_xor_b32 v202, v186, v7
    v_xor_b32 v203, v187, v7
    v_pk_mad_i16 v200, v200, s10, v13 clamp
    v_pk_mad_i16 v201, v201, s10, v13 clamp
    v_pk_mad_i16 v202, v202, s10, v13 clamp
    v_pk_mad_i16 v203, v203, s10, v13 clamp
    v_cvt_pk_bf16_f32 v136, v120, v121
    v_cvt_pk_bf16_f32 v137, v122, v123
    ds_write_b64 v237, v[136:137] offset:0
    v_cvt_pk_bf16_f32 v138, v124, v125
    v_cvt_pk_bf16_f32 v139, v126, v127
    ds_write_b64 v237, v[138:139] offset:128
    v_cvt_pk_bf16_f32 v140, v128, v129
    v_cvt_pk_bf16_f32 v141, v130, v131
    ds_write_b64 v237, v[140:141] offset:256
    v_cvt_pk_bf16_f32 v142, v132, v133
    v_cvt_pk_bf16_f32 v143, v134, v135
    ds_write_b64 v237, v[142:143] offset:384
    s_cmp_eq_u32 s96, 56
    s_cbranch_scc1 kb_finA
    v_mfma_f32_16x16x32_bf16 v[120:123], v[74:77], v[200:203], 0
    v_mfma_f32_16x16x32_bf16 v[124:127], v[160:163], v[200:203], 0
    v_mfma_f32_16x16x32_bf16 v[128:131], v[164:167], v[200:203], 0
    v_mfma_f32_16x16x32_bf16 v[132:135], v[168:171], v[200:203], 0
    v_add_u32 v237, s13, v237
    v_add_u32 v239, s13, v239
    v_subrev_u32 v238, s13, v238
    s_sub_u32 s13, 0, s13
    s_setprio 0
    s_cmp_le_u32 s94, s93
    s_cbranch_scc1 kb_extraA
kb_nextA:
    s_max_u32 s8, s8, s93
    s_add_u32 s93, s93, 32
    s_waitcnt vmcnt(8) lgkmcnt(0)
    s_branch kb_loopA
kb_finA:
    v_subrev_u32 v238, s13, v238
    s_waitcnt lgkmcnt(0)
    s_barrier
    ds_read_b128 v[228:231], v238
    ds_read_b128 v[232:235], v238 offset:1056
    s_waitcnt lgkmcnt(0)
    buffer_store_dwordx4 v[228:231], v8, s[32:35], s98 offen offset:0 sc0 sc1
    buffer_store_dwordx4 v[232:235], v236, s[32:35], s98 offen offset:2048 sc0 sc1
    v_add_u32 v238, s13, v238
    s_barrier
    s_branch kb_done
kb_extraA:
    s_waitcnt lgkmcnt(0)
    s_barrier
    ds_read_b128 v[228:231], v238
    ds_read_b128 v[232:235], v238 offset:1056
    ds_read_b64_tr_b16 v[204:205], v239 offset:0
    ds_read_b64_tr_b16 v[206:207], v239 offset:128
    ds_read_b64_tr_b16 v[208:209], v239 offset:256
    ds_read_b64_tr_b16 v[210:211], v239 offset:384
    s_waitcnt lgkmcnt(0)
    buffer_store_dwordx4 v[228:231], v8, s[32:35], s98 offen offset:0 sc0 sc1
    buffer_store_dwordx4 v[232:235], v236, s[32:35], s98 offen offset:2048 sc0 sc1
    s_sub_u32 s60, s96, 8
    s_min_u32 s60, s60, 32
    s_lshl_b32 s59, s60, 2
    s_add_u32 s59, s59, 32
    s_cmp_gt_u32 s59, s8
    s_cbranch_scc1 kb_fbxA
kb_fbrxA:
    s_set_gpr_idx_on s60, 0x1
    s_mov_b32 s98, 0x40000000
    s_waitcnt vmcnt(12)
    v_mov_b32 v212, v80
    v_mov_b32 v213, v81
    v_mov_b32 v214, v82
    v_mov_b32 v215, v83
    v_mov_b32 v216, v84
    v_mov_b32 v217, v85
    v_mov_b32 v218, v86
    v_mov_b32 v219, v87
    s_set_gpr_idx_off
    ds_write_b128 v238, v[212:215] offset:0
    ds_write_b128 v238, v[216:219] offset:1056
    s_branch kb_extrarA
kb_ownA:
    s_add_u32 s9, s9, 1
    s_add_u32 s97, s97, 14336
    s_cmp_lg_u32 s9, 4
    s_cbranch_scc1 kb_ownA_4
    buffer_load_dwordx4 v[88:91], v8, s[48:51], s97 offen offset:0
    buffer_load_dwordx4 v[92:95], v236, s[48:51], s97 offen offset:2048
    s_branch kb_ownrA
kb_ownA_4:
    s_cmp_lg_u32 s9, 5
    s_cbranch_scc1 kb_ownA_5
    buffer_load_dwordx4 v[96:99], v8, s[48:51], s97 offen offset:0
    buffer_load_dwordx4 v[100:103], v236, s[48:51], s97 offen offset:2048
    s_branch kb_ownrA
kb_ownA_5:
    s_cmp_lg_u32 s9, 6
    s_cbranch_scc1 kb_ownA_6
    buffer_load_dwordx4 v[104:107], v8, s[48:51], s97 offen offset:0
    buffer_load_dwordx4 v[108:111], v236, s[48:51], s97 offen offset:2048
    s_branch kb_ownrA
kb_ownA_6:
    s_cmp_lg_u32 s9, 7
    s_cbranch_scc1 kb_ownA_7
    buffer_load_dwordx4 v[112:115], v8, s[48:51], s97 offen offset:0
    buffer_load_dwordx4 v[116:119], v236, s[48:51], s97 offen offset:2048
    s_branch kb_ownrA
kb_ownA_7:
    s_branch kb_pret
kb_B_entry:
    s_barrier
    s_cmp_ge_u32 s9, 7
    s_cbranch_scc1 kb_ownrB0
    s_add_u32 s9, s9, 1
    s_add_u32 s97, s97, 14336
    buffer_load_dwordx4 v[88:91], v8, s[48:51], s97 offen offset:0
    buffer_load_dwordx4 v[92:95], v236, s[48:51], s97 offen offset:2048
kb_ownrB0:
    v_lshl_add_u32 v11, v10, 8, v1
    v_lshl_add_u32 v12, v10, 10, v2
    s_mov_b32 m0, s100
    ds_bpermute_b32 v10, v6, v9
    buffer_load_dwordx4 v11, s[36:39], 0 offen sc0 lds
    v_add_u32 v6, 16, v6
    s_add_u32 m0, s100, 1024
    s_nop 0
    buffer_load_dwordx4 v12, s[28:31], s56 offen sc0 lds
    s_add_u32 m0, s100, 2048
    s_nop 0
    buffer_load_dwordx4 v12, s[28:31], s57 offen sc0 lds
    s_add_u32 m0, s100, 3072
    s_nop 0
    buffer_load_dwordx4 v12, s[28:31], s58 offen sc0 lds
    s_add_u32 s100, s100, 0x8000
    s_cmp_ge_u32 s100, 0x18000
    s_cselect_b32 s18, 0x18000, 0
    s_sub_u32 s100, s100, s18
    buffer_store_dwordx4 v[228:231], v8, s[32:35], s98 offen offset:0 sc0 sc1
    buffer_store_dwordx4 v[232:235], v236, s[32:35], s98 offen offset:2048 sc0 sc1
kb_loopB:
    s_setprio 2
    ds_read_b128 v[172:175], v16
    ds_read_b128 v[176:179], v17
    ds_read_b128 v[180:183], v18
    ds_read_b128 v[184:187], v19
    ds_read_b64 v[74:75], v4
    s_waitcnt lgkmcnt(4)
    v_mfma_f32_16x16x32_bf16 v[136:139], v[172:175], v[20:23], 0
    ds_read_b128 v[188:191], v16 offset:4096
    v_mfma_f32_16x16x32_bf16 v[140:143], v[172:175], v[36:39], 0
    ds_read_b128 v[192:195], v17 offset:4096
    v_mfma_f32_16x16x32_bf16 v[144:147], v[172:175], v[52:55], 0
    ds_read_b128 v[196:199], v18 offset:4096
    s_waitcnt lgkmcnt(6)
    v_mfma_f32_16x16x32_bf16 v[136:139], v[176:179], v[24:27], v[136:139]
    ds_read_b128 v[200:203], v19 offset:4096
    v_mfma_f32_16x16x32_bf16 v[140:143], v[176:179], v[40:43], v[140:143]
    ds_read_b64 v[76:77], v4 offset:512
    v_add_u32 v16, s101, v16
    v_mfma_f32_16x16x32_bf16 v[144:147], v[176:179], v[56:59], v[144:147]
    ds_read_b64_tr_b16 v[204:205], v3 offset:1024
    v_add_u32 v17, s101, v17
    s_waitcnt lgkmcnt(8)
    v_mfma_f32_16x16x32_bf16 v[136:139], v[180:183], v[28:31], v[136:139]
    ds_read_b64_tr_b16 v[206:207], v3 offset:1536
    v_add_u32 v18, s101, v18
    v_mfma_f32_16x16x32_bf16 v[140:143], v[180:183], v[44:47], v[140:143]
    ds_read_b64_tr_b16 v[208:209], v3 offset:2048
    v_add_u32 v19, s101, v19
    v_mfma_f32_16x16x32_bf16 v[144:147], v[180:183], v[60:63], v[144:147]
    ds_read_b64_tr_b16 v[210:211], v3 offset:2560
    v_add_u32 v4, 1024, v4
    s_waitcnt lgkmcnt(10)
    v_mfma_f32_16x16x32_bf16 v[136:139], v[184:187], v[32:35], v[136:139]
    ds_read_b64_tr_b16 v[212:213], v3 offset:3072
    v_mfma_f32_16x16x32_bf16 v[140:143], v[184:187], v[48:51], v[140:143]
    ds_read_b64_tr_b16 v[214:215], v3 offset:3584
    v_mfma_f32_16x16x32_bf16 v[144:147], v[184:187], v[64:67], v[144:147]
    s_waitcnt lgkmcnt(11)
    v_mfma_f32_16x16x16_bf16 v[160:163], v[74:75], v[68:69], 0
    ds_read_b128 v[172:175], v5 offset:0
    v_mfma_f32_16x16x16_bf16 v[164:167], v[74:75], v[70:71], 0
    ds_read_b128 v[176:179], v5 offset:128
    v_mfma_f32_16x16x16_bf16 v[168:171], v[74:75], v[72:73], 0
    ds_read_b128 v[180:183], v5 offset:256
    s_waitcnt lgkmcnt(9)
    v_mfma_f32_16x16x32_bf16 v[148:151], v[188:191], v[20:23], 0
    ds_read_b64_tr_b16 v[216:217], v3 offset:5120
    v_mfma_f32_16x16x32_bf16 v[152:155], v[188:191], v[36:39], 0
    ds_read_b64_tr_b16 v[218:219], v3 offset:5632
    v_mfma_f32_16x16x32_bf16 v[156:159], v[188:191], v[52:55], 0
    ds_read_b64_tr_b16 v[220:221], v3 offset:6144
    v_mul_f32 v144, v144, v168
    v_mul_f32 v145, v145, v169
    v_mfma_f32_16x16x32_bf16 v[148:151], v[192:195], v[24:27], v[148:151]
    ds_read_b64_tr_b16 v[222:223], v3 offset:6656
    v_mul_f32 v146, v146, v170
    v_mul_f32 v147, v147, v171
    v_mfma_f32_16x16x32_bf16 v[152:155], v[192:195], v[40:43], v[152:155]
    ds_read_b64_tr_b16 v[224:225], v3 offset:7168
    v_mul_f32 v136, v136, v160
    v_mul_f32 v137, v137, v161
    v_mfma_f32_16x16x32_bf16 v[156:159], v[192:195], v[56:59], v[156:159]
    ds_read_b64_tr_b16 v[226:227], v3 offset:7680
    v_mul_f32 v138, v138, v162
    v_mul_f32 v139, v139, v163
    v_mfma_f32_16x16x32_bf16 v[148:151], v[196:199], v[28:31], v[148:151]
    s_waitcnt lgkmcnt(8)
    ds_read_b128 v[184:187], v5 offset:384
    v_mul_f32 v140, v140, v164
    v_mul_f32 v141, v141, v165
    v_add_u32 v3, s101, v3
    v_mfma_f32_16x16x32_bf16 v[152:155], v[196:199], v[44:47], v[152:155]
    v_mul_f32 v142, v142, v166
    v_mul_f32 v143, v143, v167
    s_add_u32 s19, s19, s101
    v_mfma_f32_16x16x32_bf16 v[156:159], v[196:199], v[60:63], v[156:159]
    v_cvt_pk_bf16_f32 v74, v136, v137
    v_cvt_pk_bf16_f32 v75, v138, v139
    s_cmp_eq_u32 s19, 0x10000
    s_cselect_b32 s101, 0xffff0000, s17
    v_mfma_f32_16x16x32_bf16 v[148:151], v[200:203], v[32:35], v[148:151]
    ds_read_b128 v[188:191], v5 offset:16
    s_waitcnt lgkmcnt(8)
    v_mul_f32 v172, v172, v144
    v_mul_f32 v173, v173, v145
    v_mfma_f32_16x16x32_bf16 v[152:155], v[200:203], v[48:51], v[152:155]
    ds_read_b128 v[192:195], v5 offset:144
    v_mul_f32 v174, v174, v146
    v_mul_f32 v175, v175, v147
    v_mfma_f32_16x16x32_bf16 v[156:159], v[200:203], v[64:67], v[156:159]
    ds_read_b128 v[196:199], v5 offset:272
    v_mul_f32 v176, v176, v144
    v_mul_f32 v177, v177, v145
    v_mfma_f32_16x16x16_bf16 v[160:163], v[76:77], v[68:69], 0
    v_mul_f32 v178, v178, v146
    v_mul_f32 v179, v179, v147
    v_add_u32 v5, 512, v5
    v_mfma_f32_16x16x16_bf16 v[164:167], v[76:77], v[70:71], 0
    v_mul_f32 v180, v180, v144
    v_mul_f32 v181, v181, v145
    v_mfma_f32_16x16x16_bf16 v[168:171], v[76:77], v[72:73], 0
    v_mul_f32 v182, v182, v146
    v_mul_f32 v183, v183, v147
    s_setprio 1
    s_waitcnt lgkmcnt(4)
    s_max_u32 s8, s8, s93
    s_waitcnt vmcnt(8)
    s_barrier
    s_cmp_lt_u32 s9, 7
    s_cbranch_scc1 kb_ownB
kb_ownrB:
    v_lshl_add_u32 v11, v10, 8, v1
    v_lshl_add_u32 v12, v10, 10, v2
    s_mov_b32 m0, s100
    ds_bpermute_b32 v10, v6, v9
    buffer_load_dwordx4 v11, s[36:39], 0 offen sc0 lds
    v_add_u32 v6, 16, v6
    ds_read_b128 v[228:231], v238
    ds_read_b128 v[232:235], v238 offset:1056
    s_waitcnt lgkmcnt(6)
    v_xor_b32 v200, v184, v7
    v_xor_b32 v201, v185, v7
    v_xor_b32 v202, v186, v7
    v_xor_b32 v203, v187, v7
    v_fmac_f32 v172, v204, v140
    v_fmac_f32 v173, v205, v141
    v_fmac_f32 v174, v206, v142
    v_fmac_f32 v175, v207, v143
    v_fmac_f32 v176, v208, v140
    v_fmac_f32 v177, v209, v141
    v_fmac_f32 v178, v210, v142
    v_fmac_f32 v179, v211, v143
    s_add_u32 m0, s100, 1024
    v_fmac_f32 v180, v212, v140
    buffer_load_dwordx4 v12, s[28:31], s56 offen sc0 lds
    v_fmac_f32 v181, v213, v141
    v_fmac_f32 v182, v214, v142
    v_fmac_f32 v183, v215, v143
    v_pk_mad_i16 v200, v200, s10, v13 clamp
    v_pk_mad_i16 v201, v201, s10, v13 clamp
    v_pk_mad_i16 v202, v202, s10, v13 clamp
    v_pk_mad_i16 v203, v203, s10, v13 clamp
    v_mul_f32 v148, v148, v160
    v_mul_f32 v149, v149, v161
    v_mul_f32 v150, v150, v162
    v_mul_f32 v151, v151, v163
    v_mul_f32 v152, v152, v164
    v_mul_f32 v153, v153, v165
    v_mul_f32 v154, v154, v166
    v_mul_f32 v155, v155, v167
    s_add_u32 m0, s100, 2048
    v_mul_f32 v156, v156, v168
    buffer_load_dwordx4 v12, s[28:31], s57 offen sc0 lds
    v_mul_f32 v157, v157, v169
    v_mul_f32 v158, v158, v170
    v_mul_f32 v159, v159, v171
    v_cvt_pk_bf16_f32 v76, v148, v149
    v_cvt_pk_bf16_f32 v77, v150, v151
    s_waitcnt lgkmcnt(3)
    ds_read_b64_tr_b16 v[204:205], v239 offset:0
    ds_read_b64_tr_b16 v[206:207], v239 offset:128
    ds_read_b64_tr_b16 v[208:209], v239 offset:256
    ds_read_b64_tr_b16 v[210:211], v239 offset:384
    v_mul_f32 v188, v188, v156
    v_mul_f32 v189, v189, v157
    v_mul_f32 v190, v190, v158
    v_mul_f32 v191, v191, v159
    v_fmac_f32 v188, v216, v152
    v_fmac_f32 v189, v217, v153
    v_fmac_f32 v190, v218, v154
    v_fmac_f32 v191, v219, v155
    v_cvt_pk_bf16_f32 v160, v172, v173
    v_cvt_pk_bf16_f32 v161, v174, v175
    s_add_u32 m0, s100, 3072
    v_cvt_pk_bf16_f32 v162, v188, v189
    buffer_load_dwordx4 v12, s[28:31], s58 offen sc0 lds
    s_add_u32 s100, s100, 0x8000
    s_cmp_ge_u32 s100, 0x18000
    s_cselect_b32 s18, 0x18000, 0
    s_sub_u32 s100, s100, s18
    v_cvt_pk_bf16_f32 v163, v190, v191
    v_mul_f32 v192, v192, v156
    v_mul_f32 v193, v193, v157
    v_mul_f32 v194, v194, v158
    v_mul_f32 v195, v195, v159
    v_fmac_f32 v192, v220, v152
    v_fmac_f32 v193, v221, v153
    v_fmac_f32 v194, v222, v154
    v_fmac_f32 v195, v223, v155
    v_cvt_pk_bf16_f32 v164, v176, v177
    v_cvt_pk_bf16_f32 v165, v178, v179
    v_cvt_pk_bf16_f32 v166, v192, v193
    v_cvt_pk_bf16_f32 v167, v194, v195
    v_mul_f32 v196, v196, v156
    v_mul_f32 v197, v197, v157
    v_mul_f32 v198, v198, v158
    v_mul_f32 v199, v199, v159
    v_fmac_f32 v196, v224, v152
    v_fmac_f32 v197, v225, v153
    v_fmac_f32 v198, v226, v154
    v_fmac_f32 v199, v227, v155
    v_cvt_pk_bf16_f32 v168, v180, v181
    v_cvt_pk_bf16_f32 v169, v182, v183
    v_cvt_pk_bf16_f32 v170, v196, v197
    v_cvt_pk_bf16_f32 v171, v198, v199
    s_setprio 3
    v_mfma_f32_16x16x32_bf16 v[120:123], v[74:77], v[200:203], v[120:123]
    v_mfma_f32_16x16x32_bf16 v[124:127], v[160:163], v[200:203], v[124:127]
    v_mfma_f32_16x16x32_bf16 v[128:131], v[164:167], v[200:203], v[128:131]
    v_mfma_f32_16x16x32_bf16 v[132:135], v[168:171], v[200:203], v[132:135]
    s_setprio 1
    s_waitcnt lgkmcnt(0)
    buffer_store_dwordx4 v[228:231], v8, s[32:35], s98 offen offset:0 sc0 sc1
    buffer_store_dwordx4 v[232:235], v236, s[32:35], s98 offen offset:2048 sc0 sc1
    s_bitcmp1_b32 s98, 30
    s_cbranch_scc1 kb_segendB
    s_sub_u32 s60, s96, 8
    s_min_u32 s60, s60, 32
    s_lshl_b32 s59, s60, 2
    s_add_u32 s59, s59, 32
    s_cmp_gt_u32 s59, s8
    s_cbranch_scc1 kb_fbrB
kb_fbrrB:
    s_set_gpr_idx_on s60, 0x1
    s_mov_b32 s98, 0x40000000
    s_waitcnt vmcnt(12)
    v_mov_b32 v212, v80
    v_mov_b32 v213, v81
    v_mov_b32 v214, v82
    v_mov_b32 v215, v83
    v_mov_b32 v216, v84
    v_mov_b32 v217, v85
    v_mov_b32 v218, v86
    v_mov_b32 v219, v87
    s_set_gpr_idx_off
    ds_write_b128 v238, v[212:215] offset:0
    ds_write_b128 v238, v[216:219] offset:1056
kb_segendB:
    s_cmp_gt_u32 s94, s93
    s_cbranch_scc1 kb_nextB
kb_flushB:
    s_bitcmp0_b32 s98, 30
    s_cbranch_scc1 kb_extraB
kb_extrarB:
    s_setprio 3
    v_mfma_f32_16x16x16_bf16 v[120:123], v[204:205], v[240:241], v[120:123]
    v_mfma_f32_16x16x16_bf16 v[124:127], v[206:207], v[240:241], v[124:127]
    v_mfma_f32_16x16x16_bf16 v[128:131], v[208:209], v[240:241], v[128:131]
    v_mfma_f32_16x16x16_bf16 v[132:135], v[210:211], v[240:241], v[132:135]
    v_add_u32 v7, 0x001c001c, v7
    s_mul_i32 s98, s96, 1792
    s_add_u32 s96, s96, 8
    s_lshr_b64 s[90:91], s[90:91], 9
    s_mov_b32 s95, s94
    s_and_b32 s94, s90, 0x1ff
    v_xor_b32 v200, v184, v7
    v_xor_b32 v201, v185, v7
    v_xor_b32 v202, v186, v7
    v_xor_b32 v203, v187, v7
    v_pk_mad_i16 v200, v200, s10, v13 clamp
    v_pk_mad_i16 v201, v201, s10, v13 clamp
    v_pk_mad_i16 v202, v202, s10, v13 clamp
    v_pk_mad_i16 v203, v203, s10, v13 clamp
    v_cvt_pk_bf16_f32 v136, v120, v121
    v_cvt_pk_bf16_f32 v137, v122, v123
    ds_write_b64 v237, v[136:137] offset:0
    v_cvt_pk_bf16_f32 v138, v124, v125
    v_cvt_pk_bf16_f32 v139, v126, v127
    ds_write_b64 v237, v[138:139] offset:128
    v_cvt_pk_bf16_f32 v140, v128, v129
    v_cvt_pk_bf16_f32 v141, v130, v131
    ds_write_b64 v237, v[140:141] offset:256
    v_cvt_pk_bf16_f32 v142, v132, v133
    v_cvt_pk_bf16_f32 v143, v134, v135
    ds_write_b64 v237, v[142:143] offset:384
    s_cmp_eq_u32 s96, 56
    s_cbranch_scc1 kb_finB
    v_mfma_f32_16x16x32_bf16 v[120:123], v[74:77], v[200:203], 0
    v_mfma_f32_16x16x32_bf16 v[124:127], v[160:163], v[200:203], 0
    v_mfma_f32_16x16x32_bf16 v[128:131], v[164:167], v[200:203], 0
    v_mfma_f32_16x16x32_bf16 v[132:135], v[168:171], v[200:203], 0
    v_add_u32 v237, s13, v237
    v_add_u32 v239, s13, v239
    v_subrev_u32 v238, s13, v238
    s_sub_u32 s13, 0, s13
    s_setprio 1
    s_cmp_le_u32 s94, s93
    s_cbranch_scc1 kb_extraB
kb_nextB:
    s_max_u32 s8, s8, s93
    s_add_u32 s93, s93, 32
    s_branch kb_loopB
kb_finB:
    v_subrev_u32 v238, s13, v238
    s_waitcnt lgkmcnt(0)
    s_barrier
    ds_read_b128 v[228:231], v238
    ds_read_b128 v[232:235], v238 offset:1056
    s_waitcnt lgkmcnt(0)
    buffer_store_dwordx4 v[228:231], v8, s[32:35], s98 offen offset:0 sc0 sc1
    buffer_store_dwordx4 v[232:235], v236, s[32:35], s98 offen offset:2048 sc0 sc1
    v_add_u32 v238, s13, v238
    s_branch kb_done
kb_extraB:
    s_waitcnt lgkmcnt(0)
    s_barrier
    ds_read_b128 v[228:231], v238
    ds_read_b128 v[232:235], v238 offset:1056
    ds_read_b64_tr_b16 v[204:205], v239 offset:0
    ds_read_b64_tr_b16 v[206:207], v239 offset:128
    ds_read_b64_tr_b16 v[208:209], v239 offset:256
    ds_read_b64_tr_b16 v[210:211], v239 offset:384
    s_waitcnt lgkmcnt(0)
    buffer_store_dwordx4 v[228:231], v8, s[32:35], s98 offen offset:0 sc0 sc1
    buffer_store_dwordx4 v[232:235], v236, s[32:35], s98 offen offset:2048 sc0 sc1
    s_sub_u32 s60, s96, 8
    s_min_u32 s60, s60, 32
    s_lshl_b32 s59, s60, 2
    s_add_u32 s59, s59, 32
    s_cmp_gt_u32 s59, s8
    s_cbranch_scc1 kb_fbxB
kb_fbrxB:
    s_set_gpr_idx_on s60, 0x1
    s_mov_b32 s98, 0x40000000
    s_waitcnt vmcnt(12)
    v_mov_b32 v212, v80
    v_mov_b32 v213, v81
    v_mov_b32 v214, v82
    v_mov_b32 v215, v83
    v_mov_b32 v216, v84
    v_mov_b32 v217, v85
    v_mov_b32 v218, v86
    v_mov_b32 v219, v87
    s_set_gpr_idx_off
    ds_write_b128 v238, v[212:215] offset:0
    ds_write_b128 v238, v[216:219] offset:1056
    s_branch kb_extrarB
kb_ownB:
    s_add_u32 s9, s9, 1
    s_add_u32 s97, s97, 14336
    s_cmp_lg_u32 s9, 5
    s_cbranch_scc1 kb_ownB_5
    buffer_load_dwordx4 v[96:99], v8, s[48:51], s97 offen offset:0
    buffer_load_dwordx4 v[100:103], v236, s[48:51], s97 offen offset:2048
    s_branch kb_ownrB
kb_ownB_5:
    s_cmp_lg_u32 s9, 6
    s_cbranch_scc1 kb_ownB_6
    buffer_load_dwordx4 v[104:107], v8, s[48:51], s97 offen offset:0
    buffer_load_dwordx4 v[108:111], v236, s[48:51], s97 offen offset:2048
    s_branch kb_ownrB
kb_ownB_6:
    s_cmp_lg_u32 s9, 7
    s_cbranch_scc1 kb_ownB_7
    buffer_load_dwordx4 v[112:115], v8, s[48:51], s97 offen offset:0
    buffer_load_dwordx4 v[116:119], v236, s[48:51], s97 offen offset:2048
    s_branch kb_ownrB
kb_ownB_7:
    s_branch kb_pret
kb_slow_own:
    s_waitcnt vmcnt(0)
    s_mov_b32 s62, 0
    buffer_load_dwordx4 v[104:107], v8, s[48:51], s62 offen offset:0 sc0 sc1
    buffer_load_dwordx4 v[108:111], v236, s[48:51], s62 offen offset:2048 sc0 sc1
    s_mov_b32 s62, 14336
    buffer_load_dwordx4 v[112:115], v8, s[48:51], s62 offen offset:0 sc0 sc1
    buffer_load_dwordx4 v[116:119], v236, s[48:51], s62 offen offset:2048 sc0 sc1
    s_waitcnt vmcnt(0)
    v_subrev_u32 v136, 16896, v238
    ds_write_b128 v136, v[104:107] offset:0
    ds_write_b128 v136, v[108:111] offset:1056
    ds_write_b128 v136, v[112:115] offset:16896
    ds_write_b128 v136, v[116:119] offset:17952
    s_waitcnt lgkmcnt(0)
    s_mov_b32 s62, 28672
    buffer_load_dwordx4 v[80:83], v8, s[48:51], s62 offen offset:0 sc0 sc1
    buffer_load_dwordx4 v[84:87], v236, s[48:51], s62 offen offset:2048 sc0 sc1
    s_mov_b32 s62, 43008
    buffer_load_dwordx4 v[88:91], v8, s[48:51], s62 offen offset:0 sc0 sc1
    buffer_load_dwordx4 v[92:95], v236, s[48:51], s62 offen offset:2048 sc0 sc1
    s_mov_b32 s62, 57344
    buffer_load_dwordx4 v[96:99], v8, s[48:51], s62 offen offset:0 sc0 sc1
    buffer_load_dwordx4 v[100:103], v236, s[48:51], s62 offen offset:2048 sc0 sc1
    s_mov_b32 s62, 71680
    buffer_load_dwordx4 v[104:107], v8, s[48:51], s62 offen offset:0 sc0 sc1
    buffer_load_dwordx4 v[108:111], v236, s[48:51], s62 offen offset:2048 sc0 sc1
    s_mov_b32 s62, 86016
    buffer_load_dwordx4 v[112:115], v8, s[48:51], s62 offen offset:0 sc0 sc1
    buffer_load_dwordx4 v[116:119], v236, s[48:51], s62 offen offset:2048 sc0 sc1
    s_mov_b32 s9, 7
    s_mov_b32 s8, 0x7fffffff
    s_waitcnt vmcnt(0)
    s_branch kb_slow_ownr
kb_fbrA:
    s_cmp_ge_u32 s9, 7
    s_cbranch_scc1 kb_fb2rA
    s_mov_b32 s62, 43008
    buffer_load_dwordx4 v[88:91], v8, s[48:51], s62 offen offset:0
    buffer_load_dwordx4 v[92:95], v236, s[48:51], s62 offen offset:2048
    s_mov_b32 s62, 57344
    buffer_load_dwordx4 v[96:99], v8, s[48:51], s62 offen offset:0
    buffer_load_dwordx4 v[100:103], v236, s[48:51], s62 offen offset:2048
    s_mov_b32 s62, 71680
    buffer_load_dwordx4 v[104:107], v8, s[48:51], s62 offen offset:0
    buffer_load_dwordx4 v[108:111], v236, s[48:51], s62 offen offset:2048
    s_mov_b32 s62, 86016
    buffer_load_dwordx4 v[112:115], v8, s[48:51], s62 offen offset:0
    buffer_load_dwordx4 v[116:119], v236, s[48:51], s62 offen offset:2048
kb_fb2rA:
    s_mov_b32 s9, 7
    s_mov_b32 s8, 0x7fffffff
    s_waitcnt vmcnt(0)
    s_branch kb_fbrrA
kb_fbxA:
    s_cmp_ge_u32 s9, 7
    s_cbranch_scc1 kb_fb2xA
    s_mov_b32 s62, 43008
    buffer_load_dwordx4 v[88:91], v8, s[48:51], s62 offen offset:0
    buffer_load_dwordx4 v[92:95], v236, s[48:51], s62 offen offset:2048
    s_mov_b32 s62, 57344
    buffer_load_dwordx4 v[96:99], v8, s[48:51], s62 offen offset:0
    buffer_load_dwordx4 v[100:103], v236, s[48:51], s62 offen offset:2048
    s_mov_b32 s62, 71680
    buffer_load_dwordx4 v[104:107], v8, s[48:51], s62 offen offset:0
    buffer_load_dwordx4 v[108:111], v236, s[48:51], s62 offen offset:2048
    s_mov_b32 s62, 86016
    buffer_load_dwordx4 v[112:115], v8, s[48:51], s62 offen offset:0
    buffer_load_dwordx4 v[116:119], v236, s[48:51], s62 offen offset:2048
kb_fb2xA:
    s_mov_b32 s9, 7
    s_mov_b32 s8, 0x7fffffff
    s_waitcnt vmcnt(0)
    s_branch kb_fbrxA
kb_fbrB:
    s_cmp_ge_u32 s9, 7
    s_cbranch_scc1 kb_fb2rB
    s_mov_b32 s62, 43008
    buffer_load_dwordx4 v[88:91], v8, s[48:51], s62 offen offset:0
    buffer_load_dwordx4 v[92:95], v236, s[48:51], s62 offen offset:2048
    s_mov_b32 s62, 57344
    buffer_load_dwordx4 v[96:99], v8, s[48:51], s62 offen offset:0
    buffer_load_dwordx4 v[100:103], v236, s[48:51], s62 offen offset:2048
    s_mov_b32 s62, 71680
    buffer_load_dwordx4 v[104:107], v8, s[48:51], s62 offen offset:0
    buffer_load_dwordx4 v[108:111], v236, s[48:51], s62 offen offset:2048
    s_mov_b32 s62, 86016
    buffer_load_dwordx4 v[112:115], v8, s[48:51], s62 offen offset:0
    buffer_load_dwordx4 v[116:119], v236, s[48:51], s62 offen offset:2048
kb_fb2rB:
    s_mov_b32 s9, 7
    s_mov_b32 s8, 0x7fffffff
    s_waitcnt vmcnt(0)
    s_branch kb_fbrrB
kb_fbxB:
    s_cmp_ge_u32 s9, 7
    s_cbranch_scc1 kb_fb2xB
    s_mov_b32 s62, 43008
    buffer_load_dwordx4 v[88:91], v8, s[48:51], s62 offen offset:0
    buffer_load_dwordx4 v[92:95], v236, s[48:51], s62 offen offset:2048
    s_mov_b32 s62, 57344
    buffer_load_dwordx4 v[96:99], v8, s[48:51], s62 offen offset:0
    buffer_load_dwordx4 v[100:103], v236, s[48:51], s62 offen offset:2048
    s_mov_b32 s62, 71680
    buffer_load_dwordx4 v[104:107], v8, s[48:51], s62 offen offset:0
    buffer_load_dwordx4 v[108:111], v236, s[48:51], s62 offen offset:2048
    s_mov_b32 s62, 86016
    buffer_load_dwordx4 v[112:115], v8, s[48:51], s62 offen offset:0
    buffer_load_dwordx4 v[116:119], v236, s[48:51], s62 offen offset:2048
kb_fb2xB:
    s_mov_b32 s9, 7
    s_mov_b32 s8, 0x7fffffff
    s_waitcnt vmcnt(0)
    s_branch kb_fbrxB
kb_go_slow:
    s_mov_b32 s55, 1
    s_mov_b32 s26, 0
    s_mov_b32 s27, 0
    s_mov_b32 s3, -1
    s_mov_b32 s88, 0
    s_mov_b32 s89, 0
    s_branch kb_copy
kb_empty:
    s_cmp_lg_u32 s55, 0
    s_cbranch_scc1 kb_done
kb_copy:
    s_mov_b64 s[90:91], 0
    s_mov_b32 s96, 0
    s_mov_b32 s94, 0
    s_mov_b32 s92, 0
    s_mov_b32 s98, 0x40000000
    s_mov_b32 s93, 32
    s_mov_b32 s9, 7
    s_mov_b32 s8, 0x7fffffff
    s_mov_b32 s62, 0
    buffer_load_dwordx4 v[104:107], v8, s[48:51], s62 offen offset:0
    buffer_load_dwordx4 v[108:111], v236, s[48:51], s62 offen offset:2048
    s_mov_b32 s62, 14336
    buffer_load_dwordx4 v[112:115], v8, s[48:51], s62 offen offset:0
    buffer_load_dwordx4 v[116:119], v236, s[48:51], s62 offen offset:2048
    s_waitcnt vmcnt(0)
    v_subrev_u32 v136, 16896, v238
    ds_write_b128 v136, v[104:107] offset:0
    ds_write_b128 v136, v[108:111] offset:1056
    ds_write_b128 v136, v[112:115] offset:16896
    ds_write_b128 v136, v[116:119] offset:17952
    s_waitcnt lgkmcnt(0)
    s_mov_b32 s62, 28672
    buffer_load_dwordx4 v[80:83], v8, s[48:51], s62 offen offset:0
    buffer_load_dwordx4 v[84:87], v236, s[48:51], s62 offen offset:2048
    s_mov_b32 s62, 43008
    buffer_load_dwordx4 v[88:91], v8, s[48:51], s62 offen offset:0
    buffer_load_dwordx4 v[92:95], v236, s[48:51], s62 offen offset:2048
    s_mov_b32 s62, 57344
    buffer_load_dwordx4 v[96:99], v8, s[48:51], s62 offen offset:0
    buffer_load_dwordx4 v[100:103], v236, s[48:51], s62 offen offset:2048
    s_mov_b32 s62, 71680
    buffer_load_dwordx4 v[104:107], v8, s[48:51], s62 offen offset:0
    buffer_load_dwordx4 v[108:111], v236, s[48:51], s62 offen offset:2048
    s_mov_b32 s62, 86016
    buffer_load_dwordx4 v[112:115], v8, s[48:51], s62 offen offset:0
    buffer_load_dwordx4 v[116:119], v236, s[48:51], s62 offen offset:2048
    s_mov_b32 s13, 16896
    s_barrier
    v_mov_b32 v74, 0
    v_mov_b32 v160, 0
    v_mov_b32 v164, 0
    v_mov_b32 v168, 0
    v_mov_b32 v184, 0
    v_mov_b32 v75, 0
    v_mov_b32 v161, 0
    v_mov_b32 v165, 0
    v_mov_b32 v169, 0
    v_mov_b32 v185, 0
    v_mov_b32 v76, 0
    v_mov_b32 v162, 0
    v_mov_b32 v166, 0
    v_mov_b32 v170, 0
    v_mov_b32 v186, 0
    v_mov_b32 v77, 0
    v_mov_b32 v163, 0
    v_mov_b32 v167, 0
    v_mov_b32 v171, 0
    v_mov_b32 v187, 0
    v_mov_b32 v7, 0
    ds_read_b64_tr_b16 v[204:205], v239 offset:0
    ds_read_b64_tr_b16 v[206:207], v239 offset:128
    ds_read_b64_tr_b16 v[208:209], v239 offset:256
    ds_read_b64_tr_b16 v[210:211], v239 offset:384
    v_mov_b32 v120, 0
    v_mov_b32 v121, 0
    v_mov_b32 v122, 0
    v_mov_b32 v123, 0
    v_mov_b32 v124, 0
    v_mov_b32 v125, 0
    v_mov_b32 v126, 0
    v_mov_b32 v127, 0
    v_mov_b32 v128, 0
    v_mov_b32 v129, 0
    v_mov_b32 v130, 0
    v_mov_b32 v131, 0
    v_mov_b32 v132, 0
    v_mov_b32 v133, 0
    v_mov_b32 v134, 0
    v_mov_b32 v135, 0
    s_waitcnt vmcnt(0) lgkmcnt(0)
    s_branch kb_flushA
kb_done:
    s_waitcnt vmcnt(2)
    s_cmp_eq_u32 s55, 0
    s_cbranch_scc1 kb_exit
    s_waitcnt vmcnt(0) lgkmcnt(0)
    s_barrier
    v_and_b32 v144, 7, v0
    v_lshlrev_b32 v144, 2, v144
    v_add_u32 v144, 135680, v144
    v_mov_b32 v145, 0
    ds_write_b32 v144, v145
    s_mov_b32 s48, s20
    s_mov_b32 s49, s21
    s_cmp_ge_u32 s26, 4
    s_cbranch_scc1 kb_mode2
    s_lshl_b32 s59, s2, 13
    s_add_u32 s59, s59, 262144
    v_lshl_add_u32 v140, v0, 4, s59
    v_and_b32 v142, -64, v140
    s_lshl_b32 s60, s26, 2
    buffer_load_dword v208, v142, s[44:47], 0 offen
    buffer_load_dword v204, v140, s[44:47], s60 offen
    v_lshrrev_b32 v139, 7, v0
    v_cmp_eq_u32 s[80:81], s27, v139
    v_and_b32 v141, 3, v0
    v_add_u32 v141, s60, v141
    v_lshlrev_b32 v141, 2, v141
    v_cmp_ne_u32 vcc, 0, v141
    s_and_b64 s[80:81], vcc, s[80:81]
    s_waitcnt vmcnt(0)
    v_and_b32 v208, 0xffff, v208
    v_cmp_lt_u32 vcc, v141, v208
    s_and_b64 s[80:81], vcc, s[80:81]
    s_add_u32 s27, s27, 1
    s_lshr_b32 s59, s27, 2
    s_add_u32 s26, s26, s59
    s_and_b32 s27, s27, 3
    s_branch kb_round
kb_mode2:
    s_cmp_lt_u32 s89, s88
    s_cbranch_scc1 kb_m2_go
    s_add_u32 s3, s3, 1
    s_cmp_ge_u32 s3, 128
    s_cbranch_scc1 kb_exit
    s_lshl_b32 s59, s2, 13
    s_lshl_b32 s60, s3, 6
    s_add_u32 s59, s59, s60
    s_add_u32 s59, s59, 6815744
    s_load_dword s60, s[24:25], s59
    s_waitcnt lgkmcnt(0)
    s_and_b32 s61, s60, 0xffff
    s_lshr_b32 s88, s60, 16
    s_cmp_gt_u32 s61, 64
    s_cselect_b32 s88, s88, 0
    s_mov_b32 s89, 0
    s_branch kb_mode2
kb_m2_go:
    v_add_u32 v139, s89, v0
    v_cmp_gt_u32 s[80:81], s88, v139
    v_cmp_gt_u32 vcc, 128, v0
    s_and_b64 s[80:81], vcc, s[80:81]
    s_mov_b64 vcc, s[80:81]
    s_mul_i32 s59, s3, 12544
    s_add_u32 s59, s59, 3932160
    v_lshl_add_u32 v140, v139, 2, s59
    v_mov_b32 v141, 0x40000000
    v_cndmask_b32 v140, v141, v140, vcc
    buffer_load_dword v204, v140, s[44:47], 0 offen
    s_waitcnt vmcnt(0)
    v_lshrrev_b32 v139, 16, v204
    v_subrev_u32 v139, s54, v139
    v_cmp_gt_u32 vcc, 98, v139
    s_and_b64 s[80:81], vcc, s[80:81]
    s_add_u32 s89, s89, 128
kb_round:
    s_mov_b64 s[82:83], 0
    v_mov_b32 v208, 0
    s_waitcnt lgkmcnt(0)
    s_barrier
    s_branch kb_propose
kb_exit:
    s_endpgm
.section .rodata,"a"
.p2align 6
.amdhsa_kernel ka_kernel
  .amdhsa_next_free_vgpr 144
  .amdhsa_next_free_sgpr 67
  .amdhsa_accum_offset 144
  .amdhsa_group_segment_fixed_size 0
  .amdhsa_kernarg_size 88
  .amdhsa_user_sgpr_count 2
  .amdhsa_user_sgpr_kernarg_segment_ptr 1
  .amdhsa_system_sgpr_workgroup_id_x 1
.end_amdhsa_kernel
.p2align 6
.amdhsa_kernel kb_kernel
  .amdhsa_next_free_vgpr 248
  .amdhsa_next_free_sgpr 102
  .amdhsa_accum_offset 248
  .amdhsa_group_segment_fixed_size 0
  .amdhsa_kernarg_size 88
  .amdhsa_user_sgpr_count 2
  .amdhsa_user_sgpr_kernarg_segment_ptr 1
  .amdhsa_system_sgpr_workgroup_id_x 1
.end_amdhsa_kernel
```
